```python
import torch

def _softmax(x, axis=-1):
    return torch.softmax(x, dim=axis)

def _gelu(x):
    return torch.nn.functional.gelu(x, approximate='tanh')

def _silu(x):
    return torch.nn.functional.silu(x)

def _sigmoid(x):
    return torch.sigmoid(x)

def _layernorm(x, axis=-1, eps=1e-05):
    m = x.mean(dim=axis, keepdim=True)
    v = x.var(dim=axis, keepdim=True, unbiased=False)
    return (x - m) / torch.sqrt(v + eps)

def _scatter_add(tgt, idx, src, axis=0):
    return tgt.clone().index_add_(axis, idx, src)

def _segment_sum(src, seg, n):
    out = torch.zeros((n,) + src.shape[1:], dtype=src.dtype)
    return out.index_add_(0, seg, src)

def _pad(x, pw):
    flat = tuple((v for pair in reversed(pw) for v in pair))
    return torch.nn.functional.pad(x, flat)
kernel_name = 'standalone__molecular_angular_painn__graph'

def setup_inputs():

    _w = lambda a: (lambda t: t.to(torch.bfloat16) if t.is_floating_point() else t)(torch.as_tensor(a))
    N, deg, D = (10000, 16, 256)
    n_rbf = max(0, 4)
    E = N * deg
    cutoff = 5.0
    freqs = (torch.arange(1, n_rbf + 1) * torch.pi / cutoff).to(float)
    return {'sv': _w((lambda *s: torch.randn(*s, dtype=torch.bfloat16) * 0.4)(N, 4, D) * 0.3), 'pos': _w((lambda *s: torch.randn(*s, dtype=torch.bfloat16) * 3.2)(N, 3) * 1.2), 'src': _w((lambda lo, hi, *s: torch.randint(lo, hi, s))(0, N, E).to(torch.int64)), 'dst': _w((lambda lo, hi, *s: torch.randint(lo, hi, s))(0, N, E).to(torch.int64)), 'freqs': _w(freqs), 'w_phi1': _w((lambda *s: torch.randn(*s, dtype=torch.bfloat16) * 3.2)(D, D) / D ** 0.5), 'w_phi2': _w((lambda *s: torch.randn(*s, dtype=torch.bfloat16) * 3.2)(D, 3 * D) / D ** 0.5), 'w_rbf': _w((lambda *s: torch.randn(*s, dtype=torch.bfloat16) * 3.2)(n_rbf, 3 * D) / n_rbf ** 0.5)}

def reference(sv, pos, src, dst, freqs, w_phi1, w_phi2, w_rbf):
    N, _, D = sv.shape
    E = src.shape[0]
    PI, cutoff = (3.141592653589793, 5.0)
    s, v = (sv[:, 0, :].clone(), sv[:, 1:, :].clone())
    r_vec = pos[src] - pos[dst]
    d = torch.sqrt((r_vec * r_vec).sum(-1) + 1e-08)
    r_hat = r_vec / d[:, None]
    rbf = torch.sin(d[:, None] * freqs[None, :]) / d[:, None]
    fcut = 0.5 * (torch.cos(PI * d / cutoff) + 1.0)
    fcut = torch.where(d < cutoff, fcut, 0.0 * d)
    Wf = rbf @ w_rbf * fcut[:, None]
    phi = (_silu(s @ w_phi1) @ w_phi2)[src]
    m = phi * Wf
    m_s, m_vv, m_vr = (m[:, :D].clone(), m[:, D:2 * D].clone(), m[:, 2 * D:].clone())
    ds = _segment_sum(m_s, dst, N)
    dv_e = m_vv[:, None, :] * v[src] + m_vr[:, None, :] * r_hat[:, :, None]
    dv = _segment_sum(dv_e.reshape(E, 3 * D), dst, N).reshape(N, 3, D)
    return sv + torch.concatenate([ds[:, None, :], dv], axis=1)
```

```asm
; @launch kernel=k1_kernel grid=(253,1,1) block=(512,1,1) lds=163840
; @launch kernel=k2_kernel grid=(1000,1,1) block=(256,1,1) lds=30016
.amdgcn_target "amdgcn-amd-amdhsa--gfx950"
.text
.globl k1_kernel
.p2align 8
.type k1_kernel,@function
k1_kernel:
  s_cmp_ge_u32 s2, 253
  s_cbranch_scc1 L_k1_exit
  s_cmp_ge_u32 s2, 96
  s_cbranch_scc1 L_k1_mlp
  s_cmp_ge_u32 s2, 40
  s_cbranch_scc1 L_k1_pf
  s_load_dwordx4 s[4:7], s[0:1], 8
  s_load_dwordx4 s[8:11], s[0:1], 24
  s_load_dwordx4 s[12:15], s[0:1], 72
  v_and_b32 v1, 63, v0
  v_lshrrev_b32 v2, 6, v0
  s_nop 0
  v_readfirstlane_b32 s3, v2
  s_lshl_b32 s40, s2, 12
  s_lshl_b32 s41, s3, 9
  s_add_u32 s40, s40, s41
  v_lshlrev_b32 v5, 2, v1
  v_add_u32 v5, s40, v5
  v_lshlrev_b32 v6, 2, v5
  v_lshlrev_b32 v7, 4, v1
  s_lshl_b32 s41, s3, 12
  v_add_u32 v7, s41, v7
  s_lshl_b32 s40, s2, 9
  v_add_u32 v3, s40, v0
  v_lshlrev_b32 v3, 2, v3
  v_mov_b32 v4, 0
  s_waitcnt lgkmcnt(0)
  s_add_u32 s28, s14, 0x1000000
  s_addc_u32 s29, s15, 0
  s_mov_b32 s30, 40256
  s_mov_b32 s31, 0x20000
  buffer_store_dword v4, v3, s[28:31], 0 offen sc1
  s_add_u32 s32, s14, 0x1100000
  s_addc_u32 s33, s15, 0
  s_mov_b32 s34, 1280000
  s_mov_b32 s35, 0x20000
  v_mov_b32 v8, 0
  v_mov_b32 v9, 0
  v_mov_b32 v10, 0
  v_mov_b32 v11, 0xffff0000
  v_lshlrev_b32 v12, 2, v3
  buffer_store_dwordx4 v[8:11], v12, s[32:35], 0 offen sc0 sc1
  v_add_u32 v12, 327680, v12
  buffer_store_dwordx4 v[8:11], v12, s[32:35], 0 offen sc0 sc1
  v_add_u32 v12, 327680, v12
  buffer_store_dwordx4 v[8:11], v12, s[32:35], 0 offen sc0 sc1
  v_add_u32 v12, 327680, v12
  buffer_store_dwordx4 v[8:11], v12, s[32:35], 0 offen sc0 sc1
  s_mov_b32 s20, s6
  s_mov_b32 s21, s7
  s_mov_b32 s22, 640000
  s_mov_b32 s23, 0x20000
  s_mov_b32 s24, s8
  s_mov_b32 s25, s9
  s_mov_b32 s26, 640000
  s_mov_b32 s27, 0x20000
  s_mov_b32 s16, s4
  s_mov_b32 s17, s5
  s_mov_b32 s18, 60000
  s_mov_b32 s19, 0x20000
  buffer_load_dwordx4 v[16:19], v6, s[20:23], 0 offen offset:0 nt
  buffer_load_dwordx4 v[24:27], v6, s[24:27], 0 offen offset:0 nt
  buffer_load_dwordx4 v[20:23], v6, s[20:23], 0 offen offset:1024 nt
  buffer_load_dwordx4 v[28:31], v6, s[24:27], 0 offen offset:1024 nt
  s_mov_b32 m0, s41
  s_nop 0
  buffer_load_dwordx4 v7, s[16:19], 0 offen offset:0 lds
  buffer_load_dwordx4 v7, s[16:19], 0 offen offset:1024 lds
  buffer_load_dwordx4 v7, s[16:19], 0 offen offset:2048 lds
  buffer_load_dwordx4 v7, s[16:19], 0 offen offset:3072 lds
  s_cmp_eq_u32 s3, 7
  s_cbranch_scc1 L_e_dma_done
  s_add_u32 m0, s41, 32768
  v_add_u32 v7, 32768, v7
  buffer_load_dwordx4 v7, s[16:19], 0 offen offset:0 lds
  buffer_load_dwordx4 v7, s[16:19], 0 offen offset:1024 lds
  buffer_load_dwordx4 v7, s[16:19], 0 offen offset:2048 lds
  buffer_load_dwordx4 v7, s[16:19], 0 offen offset:3072 lds
L_e_dma_done:
  s_load_dwordx2 s[44:45], s[10:11], 0
  s_add_u32 s36, s14, 0x1800000
  s_addc_u32 s37, s15, 0
  s_mov_b32 s38, 5120000
  s_mov_b32 s39, 0x20000
  s_add_u32 s52, s14, 0x1240000
  s_addc_u32 s53, s15, 0
  s_mov_b32 s54, 3840000
  s_mov_b32 s55, 0x20000
  s_mov_b32 s42, 160000
  v_add_u32 v8, 0, v5
  v_cmp_gt_u32 s[48:49], s42, v8
  v_add_u32 v8, 256, v5
  v_cmp_gt_u32 s[50:51], s42, v8
  v_mov_b32 v32, 0
  v_mov_b32 v33, 0
  v_mov_b32 v34, 0
  v_mov_b32 v35, 0
  v_mov_b32 v36, 0
  v_mov_b32 v37, 0
  v_mov_b32 v38, 0
  v_mov_b32 v39, 0
  v_mov_b32 v40, 0
  v_mov_b32 v41, 0
  v_mov_b32 v42, 0
  v_mov_b32 v43, 0
  v_mov_b32 v44, 0
  v_mov_b32 v45, 0
  v_mov_b32 v46, 0
  v_mov_b32 v47, 0
  v_mov_b32 v48, 0
  v_mov_b32 v49, 0
  v_mov_b32 v50, 0
  v_mov_b32 v51, 0
  v_mov_b32 v52, 0
  v_mov_b32 v53, 0
  v_mov_b32 v54, 0
  v_mov_b32 v55, 0
  s_waitcnt vmcnt(0)
  s_waitcnt lgkmcnt(0)
  s_barrier
  v_cmp_eq_u32 vcc, 0, v0
  s_nop 0
  s_and_saveexec_b64 s[56:57], vcc
  s_cbranch_execz L_e_sig_done
  v_mov_b32 v8, 0
  v_mov_b32 v9, 1
  global_atomic_add v8, v9, s[12:13]
L_e_sig_done:
  s_mov_b64 exec, s[56:57]
  s_lshl_b32 s43, s3, 11
  s_add_u32 s43, s43, 61440
  s_mov_b32 s58, s43
  s_mov_b32 s59, 0x41c80000
  v_mul_u32_u24 v8, 6, v16
  v_mul_u32_u24 v9, 6, v24
  v_mul_u32_u24 v10, 6, v17
  v_mul_u32_u24 v11, 6, v25
  v_mul_u32_u24 v12, 6, v18
  v_mul_u32_u24 v13, 6, v26
  v_mul_u32_u24 v14, 6, v19
  v_mul_u32_u24 v15, 6, v27
  ds_read_u16_d16_hi v32, v8 offset:0
  ds_read_u16_d16_hi v33, v8 offset:2
  ds_read_u16_d16_hi v34, v8 offset:4
  ds_read_u16_d16_hi v35, v9 offset:0
  ds_read_u16_d16_hi v36, v9 offset:2
  ds_read_u16_d16_hi v37, v9 offset:4
  ds_read_u16_d16_hi v38, v10 offset:0
  ds_read_u16_d16_hi v39, v10 offset:2
  ds_read_u16_d16_hi v40, v10 offset:4
  ds_read_u16_d16_hi v41, v11 offset:0
  ds_read_u16_d16_hi v42, v11 offset:2
  ds_read_u16_d16_hi v43, v11 offset:4
  ds_read_u16_d16_hi v44, v12 offset:0
  ds_read_u16_d16_hi v45, v12 offset:2
  ds_read_u16_d16_hi v46, v12 offset:4
  ds_read_u16_d16_hi v47, v13 offset:0
  ds_read_u16_d16_hi v48, v13 offset:2
  ds_read_u16_d16_hi v49, v13 offset:4
  ds_read_u16_d16_hi v50, v14 offset:0
  ds_read_u16_d16_hi v51, v14 offset:2
  ds_read_u16_d16_hi v52, v14 offset:4
  ds_read_u16_d16_hi v53, v15 offset:0
  ds_read_u16_d16_hi v54, v15 offset:2
  ds_read_u16_d16_hi v55, v15 offset:4
  s_waitcnt lgkmcnt(15)
  v_sub_f32 v56, v32, v35
  v_sub_f32 v57, v33, v36
  v_sub_f32 v58, v34, v37
  v_mul_f32 v56, v56, v56
  v_fmac_f32 v56, v57, v57
  v_fmac_f32 v56, v58, v58
  v_lshl_or_b32 v59, v24, 16, v16
  v_cmp_gt_f32 vcc, s59, v56
  s_nop 0
  s_and_b64 vcc, vcc, s[48:49]
  v_mbcnt_lo_u32_b32 v60, vcc_lo, 0
  v_mbcnt_hi_u32_b32 v60, vcc_hi, v60
  v_lshl_add_u32 v60, v60, 2, s43
  s_mov_b64 exec, vcc
  ds_write_b32 v60, v59
  s_mov_b64 exec, -1
  s_bcnt1_i32_b64 s60, vcc
  s_lshl_b32 s60, s60, 2
  s_add_u32 s43, s43, s60
  s_waitcnt lgkmcnt(12)
  v_sub_f32 v56, v38, v41
  v_sub_f32 v57, v39, v42
  v_sub_f32 v58, v40, v43
  v_mul_f32 v56, v56, v56
  v_fmac_f32 v56, v57, v57
  v_fmac_f32 v56, v58, v58
  v_lshl_or_b32 v59, v25, 16, v17
  v_cmp_gt_f32 vcc, s59, v56
  s_nop 0
  s_and_b64 vcc, vcc, s[48:49]
  v_mbcnt_lo_u32_b32 v60, vcc_lo, 0
  v_mbcnt_hi_u32_b32 v60, vcc_hi, v60
  v_lshl_add_u32 v60, v60, 2, s43
  s_mov_b64 exec, vcc
  ds_write_b32 v60, v59
  s_mov_b64 exec, -1
  s_bcnt1_i32_b64 s60, vcc
  s_lshl_b32 s60, s60, 2
  s_add_u32 s43, s43, s60
  s_waitcnt lgkmcnt(6)
  v_sub_f32 v56, v44, v47
  v_sub_f32 v57, v45, v48
  v_sub_f32 v58, v46, v49
  v_mul_f32 v56, v56, v56
  v_fmac_f32 v56, v57, v57
  v_fmac_f32 v56, v58, v58
  v_lshl_or_b32 v59, v26, 16, v18
  v_cmp_gt_f32 vcc, s59, v56
  s_nop 0
  s_and_b64 vcc, vcc, s[48:49]
  v_mbcnt_lo_u32_b32 v60, vcc_lo, 0
  v_mbcnt_hi_u32_b32 v60, vcc_hi, v60
  v_lshl_add_u32 v60, v60, 2, s43
  s_mov_b64 exec, vcc
  ds_write_b32 v60, v59
  s_mov_b64 exec, -1
  s_bcnt1_i32_b64 s60, vcc
  s_lshl_b32 s60, s60, 2
  s_add_u32 s43, s43, s60
  s_waitcnt lgkmcnt(0)
  v_sub_f32 v56, v50, v53
  v_sub_f32 v57, v51, v54
  v_sub_f32 v58, v52, v55
  v_mul_f32 v56, v56, v56
  v_fmac_f32 v56, v57, v57
  v_fmac_f32 v56, v58, v58
  v_lshl_or_b32 v59, v27, 16, v19
  v_cmp_gt_f32 vcc, s59, v56
  s_nop 0
  s_and_b64 vcc, vcc, s[48:49]
  v_mbcnt_lo_u32_b32 v60, vcc_lo, 0
  v_mbcnt_hi_u32_b32 v60, vcc_hi, v60
  v_lshl_add_u32 v60, v60, 2, s43
  s_mov_b64 exec, vcc
  ds_write_b32 v60, v59
  s_mov_b64 exec, -1
  s_bcnt1_i32_b64 s60, vcc
  s_lshl_b32 s60, s60, 2
  s_add_u32 s43, s43, s60
  v_mul_u32_u24 v8, 6, v20
  v_mul_u32_u24 v9, 6, v28
  v_mul_u32_u24 v10, 6, v21
  v_mul_u32_u24 v11, 6, v29
  v_mul_u32_u24 v12, 6, v22
  v_mul_u32_u24 v13, 6, v30
  v_mul_u32_u24 v14, 6, v23
  v_mul_u32_u24 v15, 6, v31
  ds_read_u16_d16_hi v32, v8 offset:0
  ds_read_u16_d16_hi v33, v8 offset:2
  ds_read_u16_d16_hi v34, v8 offset:4
  ds_read_u16_d16_hi v35, v9 offset:0
  ds_read_u16_d16_hi v36, v9 offset:2
  ds_read_u16_d16_hi v37, v9 offset:4
  ds_read_u16_d16_hi v38, v10 offset:0
  ds_read_u16_d16_hi v39, v10 offset:2
  ds_read_u16_d16_hi v40, v10 offset:4
  ds_read_u16_d16_hi v41, v11 offset:0
  ds_read_u16_d16_hi v42, v11 offset:2
  ds_read_u16_d16_hi v43, v11 offset:4
  ds_read_u16_d16_hi v44, v12 offset:0
  ds_read_u16_d16_hi v45, v12 offset:2
  ds_read_u16_d16_hi v46, v12 offset:4
  ds_read_u16_d16_hi v47, v13 offset:0
  ds_read_u16_d16_hi v48, v13 offset:2
  ds_read_u16_d16_hi v49, v13 offset:4
  ds_read_u16_d16_hi v50, v14 offset:0
  ds_read_u16_d16_hi v51, v14 offset:2
  ds_read_u16_d16_hi v52, v14 offset:4
  ds_read_u16_d16_hi v53, v15 offset:0
  ds_read_u16_d16_hi v54, v15 offset:2
  ds_read_u16_d16_hi v55, v15 offset:4
  s_waitcnt lgkmcnt(15)
  v_sub_f32 v56, v32, v35
  v_sub_f32 v57, v33, v36
  v_sub_f32 v58, v34, v37
  v_mul_f32 v56, v56, v56
  v_fmac_f32 v56, v57, v57
  v_fmac_f32 v56, v58, v58
  v_lshl_or_b32 v59, v28, 16, v20
  v_cmp_gt_f32 vcc, s59, v56
  s_nop 0
  s_and_b64 vcc, vcc, s[50:51]
  v_mbcnt_lo_u32_b32 v60, vcc_lo, 0
  v_mbcnt_hi_u32_b32 v60, vcc_hi, v60
  v_lshl_add_u32 v60, v60, 2, s43
  s_mov_b64 exec, vcc
  ds_write_b32 v60, v59
  s_mov_b64 exec, -1
  s_bcnt1_i32_b64 s60, vcc
  s_lshl_b32 s60, s60, 2
  s_add_u32 s43, s43, s60
  s_waitcnt lgkmcnt(12)
  v_sub_f32 v56, v38, v41
  v_sub_f32 v57, v39, v42
  v_sub_f32 v58, v40, v43
  v_mul_f32 v56, v56, v56
  v_fmac_f32 v56, v57, v57
  v_fmac_f32 v56, v58, v58
  v_lshl_or_b32 v59, v29, 16, v21
  v_cmp_gt_f32 vcc, s59, v56
  s_nop 0
  s_and_b64 vcc, vcc, s[50:51]
  v_mbcnt_lo_u32_b32 v60, vcc_lo, 0
  v_mbcnt_hi_u32_b32 v60, vcc_hi, v60
  v_lshl_add_u32 v60, v60, 2, s43
  s_mov_b64 exec, vcc
  ds_write_b32 v60, v59
  s_mov_b64 exec, -1
  s_bcnt1_i32_b64 s60, vcc
  s_lshl_b32 s60, s60, 2
  s_add_u32 s43, s43, s60
  s_waitcnt lgkmcnt(6)
  v_sub_f32 v56, v44, v47
  v_sub_f32 v57, v45, v48
  v_sub_f32 v58, v46, v49
  v_mul_f32 v56, v56, v56
  v_fmac_f32 v56, v57, v57
  v_fmac_f32 v56, v58, v58
  v_lshl_or_b32 v59, v30, 16, v22
  v_cmp_gt_f32 vcc, s59, v56
  s_nop 0
  s_and_b64 vcc, vcc, s[50:51]
  v_mbcnt_lo_u32_b32 v60, vcc_lo, 0
  v_mbcnt_hi_u32_b32 v60, vcc_hi, v60
  v_lshl_add_u32 v60, v60, 2, s43
  s_mov_b64 exec, vcc
  ds_write_b32 v60, v59
  s_mov_b64 exec, -1
  s_bcnt1_i32_b64 s60, vcc
  s_lshl_b32 s60, s60, 2
  s_add_u32 s43, s43, s60
  s_waitcnt lgkmcnt(0)
  v_sub_f32 v56, v50, v53
  v_sub_f32 v57, v51, v54
  v_sub_f32 v58, v52, v55
  v_mul_f32 v56, v56, v56
  v_fmac_f32 v56, v57, v57
  v_fmac_f32 v56, v58, v58
  v_lshl_or_b32 v59, v31, 16, v23
  v_cmp_gt_f32 vcc, s59, v56
  s_nop 0
  s_and_b64 vcc, vcc, s[50:51]
  v_mbcnt_lo_u32_b32 v60, vcc_lo, 0
  v_mbcnt_hi_u32_b32 v60, vcc_hi, v60
  v_lshl_add_u32 v60, v60, 2, s43
  s_mov_b64 exec, vcc
  ds_write_b32 v60, v59
  s_mov_b64 exec, -1
  s_bcnt1_i32_b64 s60, vcc
  s_lshl_b32 s60, s60, 2
  s_add_u32 s43, s43, s60
L_e_poll:
  v_mov_b32 v8, 0
  global_load_dword v9, v8, s[12:13] sc1
  s_waitcnt vmcnt(0)
  v_readfirstlane_b32 s60, v9
  s_nop 0
  s_cmp_ge_u32 s60, 40
  s_cbranch_scc1 L_e_poll_done
  s_sleep 2
  s_branch L_e_poll
L_e_poll_done:
  s_waitcnt lgkmcnt(0)
  s_lshl_b32 s61, s44, 16
  s_and_b32 s62, s44, 0xffff0000
  s_lshl_b32 s63, s45, 16
  s_and_b32 s64, s45, 0xffff0000
  s_mov_b32 s65, 0x40a00000
L_e_p2:
  s_cmp_ge_u32 s58, s43
  s_cbranch_scc1 L_e_done
  v_lshl_add_u32 v8, v1, 2, s58
  v_add_u32 v9, 256, v8
  v_cmp_gt_u32 s[66:67], s43, v8
  v_cmp_gt_u32 s[70:71], s43, v9
  ds_read_b32 v10, v8
  ds_read_b32 v11, v9
  s_add_u32 s58, s58, 512
  s_waitcnt lgkmcnt(0)
  v_cndmask_b32 v10, 0, v10, s[66:67]
  v_and_b32 v64, 0xffff, v10
  v_lshrrev_b32 v65, 16, v10
  v_lshlrev_b32 v66, 2, v65
  v_mov_b32 v67, 1
  v_cndmask_b32 v11, 0, v11, s[70:71]
  v_and_b32 v96, 0xffff, v11
  v_lshrrev_b32 v97, 16, v11
  v_lshlrev_b32 v98, 2, v97
  v_mov_b32 v99, 1
  s_mov_b64 exec, s[66:67]
  buffer_atomic_add v67, v66, s[28:31], 0 offen sc0
  s_mov_b64 exec, s[70:71]
  s_cbranch_execz L_e_p2_noB
  buffer_atomic_add v99, v98, s[28:31], 0 offen sc0
L_e_p2_noB:
  s_mov_b64 exec, -1
  v_mul_u32_u24 v12, 6, v64
  v_mul_u32_u24 v13, 6, v65
  ds_read_u16_d16_hi v32, v12 offset:0
  ds_read_u16_d16_hi v33, v12 offset:2
  ds_read_u16_d16_hi v34, v12 offset:4
  ds_read_u16_d16_hi v35, v13 offset:0
  ds_read_u16_d16_hi v36, v13 offset:2
  ds_read_u16_d16_hi v37, v13 offset:4
  v_mul_u32_u24 v12, 6, v96
  v_mul_u32_u24 v13, 6, v97
  ds_read_u16_d16_hi v38, v12 offset:0
  ds_read_u16_d16_hi v39, v12 offset:2
  ds_read_u16_d16_hi v40, v12 offset:4
  ds_read_u16_d16_hi v41, v13 offset:0
  ds_read_u16_d16_hi v42, v13 offset:2
  ds_read_u16_d16_hi v43, v13 offset:4
  s_waitcnt lgkmcnt(6)
  v_sub_f32 v72, v32, v35
  v_sub_f32 v73, v33, v36
  v_sub_f32 v74, v34, v37
  v_cvt_pk_bf16_f32 v79, v72, v73
  v_lshlrev_b32 v72, 16, v79
  v_and_b32 v73, 0xffff0000, v79
  v_cvt_pk_bf16_f32 v80, v74, v74
  v_and_b32 v74, 0xffff0000, v80
  v_mul_f32 v75, v72, v72
  v_mul_f32 v76, v73, v73
  v_mul_f32 v77, v74, v74
  v_cvt_pk_bf16_f32 v79, v75, v76
  v_lshlrev_b32 v75, 16, v79
  v_and_b32 v76, 0xffff0000, v79
  v_cvt_pk_bf16_f32 v80, v77, v77
  v_and_b32 v77, 0xffff0000, v80
  v_add_f32 v78, v75, v76
  v_add_f32 v78, v78, v77
  v_cvt_pk_bf16_f32 v79, v78, v78
  v_and_b32 v78, 0xffff0000, v79
  v_add_f32 v78, 0x322bcc77, v78
  v_cvt_pk_bf16_f32 v79, v78, v78
  v_and_b32 v78, 0xffff0000, v79
  v_sqrt_f32 v78, v78
  s_nop 0
  v_cvt_pk_bf16_f32 v79, v78, v78
  v_and_b32 v78, 0xffff0000, v79
  v_rcp_f32 v81, v78
  v_mul_f32 v85, s61, v78
  v_mul_f32 v86, s62, v78
  v_mul_f32 v87, s63, v78
  v_mul_f32 v88, s64, v78
  v_mul_f32 v89, 0x40490fdb, v78
  v_cvt_pk_bf16_f32 v79, v85, v86
  v_lshlrev_b32 v85, 16, v79
  v_and_b32 v86, 0xffff0000, v79
  v_cvt_pk_bf16_f32 v80, v87, v88
  v_lshlrev_b32 v87, 16, v80
  v_and_b32 v88, 0xffff0000, v80
  v_cvt_pk_bf16_f32 v79, v89, v89
  v_and_b32 v89, 0xffff0000, v79
  v_mul_f32 v82, v72, v81
  v_mul_f32 v83, v73, v81
  v_mul_f32 v84, v74, v81
  v_mul_f32 v85, 0.15915494, v85
  v_mul_f32 v86, 0.15915494, v86
  v_mul_f32 v87, 0.15915494, v87
  v_mul_f32 v88, 0.15915494, v88
  v_mul_f32 v89, 0x3e4ccccd, v89
  v_fract_f32 v85, v85
  v_fract_f32 v86, v86
  v_fract_f32 v87, v87
  v_fract_f32 v88, v88
  v_cvt_pk_bf16_f32 v79, v89, v89
  v_and_b32 v89, 0xffff0000, v79
  v_sin_f32 v85, v85
  v_sin_f32 v86, v86
  v_sin_f32 v87, v87
  v_sin_f32 v88, v88
  v_mul_f32 v89, 0.15915494, v89
  v_cos_f32 v89, v89
  v_cvt_pk_bf16_f32 v79, v85, v86
  v_lshlrev_b32 v85, 16, v79
  v_and_b32 v86, 0xffff0000, v79
  v_cvt_pk_bf16_f32 v80, v87, v88
  v_lshlrev_b32 v87, 16, v80
  v_and_b32 v88, 0xffff0000, v80
  v_cvt_pk_bf16_f32 v79, v89, v89
  v_and_b32 v89, 0xffff0000, v79
  v_mul_f32 v85, v85, v81
  v_mul_f32 v86, v86, v81
  v_mul_f32 v87, v87, v81
  v_mul_f32 v88, v88, v81
  v_add_f32 v89, 1.0, v89
  v_cvt_pk_bf16_f32 v79, v85, v86
  v_lshlrev_b32 v85, 16, v79
  v_and_b32 v86, 0xffff0000, v79
  v_cvt_pk_bf16_f32 v80, v87, v88
  v_lshlrev_b32 v87, 16, v80
  v_and_b32 v88, 0xffff0000, v80
  v_cvt_pk_bf16_f32 v79, v89, v89
  v_and_b32 v89, 0xffff0000, v79
  v_mul_f32 v89, 0.5, v89
  v_cmp_gt_f32 vcc, s65, v78
  s_nop 1
  v_cndmask_b32 v89, 0, v89, vcc
  v_mul_f32 v85, v85, v89
  v_mul_f32 v86, v86, v89
  v_mul_f32 v87, v87, v89
  v_mul_f32 v88, v88, v89
  v_cvt_pk_bf16_f32 v68, v85, v86
  v_cvt_pk_bf16_f32 v69, v87, v88
  v_cvt_pk_bf16_f32 v70, v82, v83
  v_cvt_pk_bf16_f32 v71, v84, v84
  v_and_b32 v71, 0xffff, v71
  v_lshl_or_b32 v71, v64, 16, v71
  s_cmp_eq_u64 s[70:71], 0
  s_cbranch_scc1 L_e_p2_skipB
  s_waitcnt lgkmcnt(0)
  v_sub_f32 v104, v38, v41
  v_sub_f32 v105, v39, v42
  v_sub_f32 v106, v40, v43
  v_cvt_pk_bf16_f32 v111, v104, v105
  v_lshlrev_b32 v104, 16, v111
  v_and_b32 v105, 0xffff0000, v111
  v_cvt_pk_bf16_f32 v112, v106, v106
  v_and_b32 v106, 0xffff0000, v112
  v_mul_f32 v107, v104, v104
  v_mul_f32 v108, v105, v105
  v_mul_f32 v109, v106, v106
  v_cvt_pk_bf16_f32 v111, v107, v108
  v_lshlrev_b32 v107, 16, v111
  v_and_b32 v108, 0xffff0000, v111
  v_cvt_pk_bf16_f32 v112, v109, v109
  v_and_b32 v109, 0xffff0000, v112
  v_add_f32 v110, v107, v108
  v_add_f32 v110, v110, v109
  v_cvt_pk_bf16_f32 v111, v110, v110
  v_and_b32 v110, 0xffff0000, v111
  v_add_f32 v110, 0x322bcc77, v110
  v_cvt_pk_bf16_f32 v111, v110, v110
  v_and_b32 v110, 0xffff0000, v111
  v_sqrt_f32 v110, v110
  s_nop 0
  v_cvt_pk_bf16_f32 v111, v110, v110
  v_and_b32 v110, 0xffff0000, v111
  v_rcp_f32 v113, v110
  v_mul_f32 v117, s61, v110
  v_mul_f32 v118, s62, v110
  v_mul_f32 v119, s63, v110
  v_mul_f32 v120, s64, v110
  v_mul_f32 v121, 0x40490fdb, v110
  v_cvt_pk_bf16_f32 v111, v117, v118
  v_lshlrev_b32 v117, 16, v111
  v_and_b32 v118, 0xffff0000, v111
  v_cvt_pk_bf16_f32 v112, v119, v120
  v_lshlrev_b32 v119, 16, v112
  v_and_b32 v120, 0xffff0000, v112
  v_cvt_pk_bf16_f32 v111, v121, v121
  v_and_b32 v121, 0xffff0000, v111
  v_mul_f32 v114, v104, v113
  v_mul_f32 v115, v105, v113
  v_mul_f32 v116, v106, v113
  v_mul_f32 v117, 0.15915494, v117
  v_mul_f32 v118, 0.15915494, v118
  v_mul_f32 v119, 0.15915494, v119
  v_mul_f32 v120, 0.15915494, v120
  v_mul_f32 v121, 0x3e4ccccd, v121
  v_fract_f32 v117, v117
  v_fract_f32 v118, v118
  v_fract_f32 v119, v119
  v_fract_f32 v120, v120
  v_cvt_pk_bf16_f32 v111, v121, v121
  v_and_b32 v121, 0xffff0000, v111
  v_sin_f32 v117, v117
  v_sin_f32 v118, v118
  v_sin_f32 v119, v119
  v_sin_f32 v120, v120
  v_mul_f32 v121, 0.15915494, v121
  v_cos_f32 v121, v121
  v_cvt_pk_bf16_f32 v111, v117, v118
  v_lshlrev_b32 v117, 16, v111
  v_and_b32 v118, 0xffff0000, v111
  v_cvt_pk_bf16_f32 v112, v119, v120
  v_lshlrev_b32 v119, 16, v112
  v_and_b32 v120, 0xffff0000, v112
  v_cvt_pk_bf16_f32 v111, v121, v121
  v_and_b32 v121, 0xffff0000, v111
  v_mul_f32 v117, v117, v113
  v_mul_f32 v118, v118, v113
  v_mul_f32 v119, v119, v113
  v_mul_f32 v120, v120, v113
  v_add_f32 v121, 1.0, v121
  v_cvt_pk_bf16_f32 v111, v117, v118
  v_lshlrev_b32 v117, 16, v111
  v_and_b32 v118, 0xffff0000, v111
  v_cvt_pk_bf16_f32 v112, v119, v120
  v_lshlrev_b32 v119, 16, v112
  v_and_b32 v120, 0xffff0000, v112
  v_cvt_pk_bf16_f32 v111, v121, v121
  v_and_b32 v121, 0xffff0000, v111
  v_mul_f32 v121, 0.5, v121
  v_cmp_gt_f32 vcc, s65, v110
  s_nop 1
  v_cndmask_b32 v121, 0, v121, vcc
  v_mul_f32 v117, v117, v121
  v_mul_f32 v118, v118, v121
  v_mul_f32 v119, v119, v121
  v_mul_f32 v120, v120, v121
  v_cvt_pk_bf16_f32 v100, v117, v118
  v_cvt_pk_bf16_f32 v101, v119, v120
  v_cvt_pk_bf16_f32 v102, v114, v115
  v_cvt_pk_bf16_f32 v103, v116, v116
  v_and_b32 v103, 0xffff, v103
  v_lshl_or_b32 v103, v96, 16, v103
L_e_p2_skipB:
  s_waitcnt vmcnt(0) lgkmcnt(0)
  v_cmp_gt_u32 vcc, 8, v67
  s_nop 0
  s_and_b64 exec, s[66:67], vcc
  v_lshlrev_b32 v12, 7, v65
  v_lshl_add_u32 v12, v67, 4, v12
  s_cbranch_execz L_e_p2_l1A
  buffer_store_dwordx4 v[68:71], v12, s[32:35], 0 offen sc0 sc1
L_e_p2_l1A:
  s_andn2_b64 exec, s[66:67], vcc
  s_cbranch_execz L_e_p2_nextA
  s_mov_b64 s[46:47], exec
  v_cmp_gt_u32 vcc, 32, v67
  s_nop 0
  s_and_b64 exec, s[46:47], vcc
  v_mul_u32_u24 v12, 384, v65
  v_lshl_add_u32 v12, v67, 4, v12
  v_subrev_u32 v12, 128, v12
  s_cbranch_execz L_e_p2_ovfA
  buffer_store_dwordx4 v[68:71], v12, s[52:55], 0 offen sc0 sc1
L_e_p2_ovfA:
  s_andn2_b64 exec, s[46:47], vcc
  s_cbranch_execz L_e_p2_nextA
  v_mov_b32 v12, 40000
  v_mov_b32 v13, 1
  buffer_atomic_add v13, v12, s[28:31], 0 offen sc0
  s_waitcnt vmcnt(0)
  v_lshlrev_b32 v12, 5, v13
  buffer_store_dwordx4 v[68:71], v12, s[36:39], 0 offen
  buffer_store_dword v65, v12, s[36:39], 0 offen offset:16
L_e_p2_nextA:
  s_mov_b64 exec, -1
  v_cmp_gt_u32 vcc, 8, v99
  s_nop 0
  s_and_b64 exec, s[70:71], vcc
  v_lshlrev_b32 v12, 7, v97
  v_lshl_add_u32 v12, v99, 4, v12
  s_cbranch_execz L_e_p2_l1B
  buffer_store_dwordx4 v[100:103], v12, s[32:35], 0 offen sc0 sc1
L_e_p2_l1B:
  s_andn2_b64 exec, s[70:71], vcc
  s_cbranch_execz L_e_p2_nextB
  s_mov_b64 s[46:47], exec
  v_cmp_gt_u32 vcc, 32, v99
  s_nop 0
  s_and_b64 exec, s[46:47], vcc
  v_mul_u32_u24 v12, 384, v97
  v_lshl_add_u32 v12, v99, 4, v12
  v_subrev_u32 v12, 128, v12
  s_cbranch_execz L_e_p2_ovfB
  buffer_store_dwordx4 v[100:103], v12, s[52:55], 0 offen sc0 sc1
L_e_p2_ovfB:
  s_andn2_b64 exec, s[46:47], vcc
  s_cbranch_execz L_e_p2_nextB
  v_mov_b32 v12, 40000
  v_mov_b32 v13, 1
  buffer_atomic_add v13, v12, s[28:31], 0 offen sc0
  s_waitcnt vmcnt(0)
  v_lshlrev_b32 v12, 5, v13
  buffer_store_dwordx4 v[100:103], v12, s[36:39], 0 offen
  buffer_store_dword v97, v12, s[36:39], 0 offen offset:16
L_e_p2_nextB:
  s_mov_b64 exec, -1
  s_branch L_e_p2
L_e_done:
  s_endpgm
L_k1_pf:
  s_load_dwordx2 s[4:5], s[0:1], 0
  v_and_b32 v1, 63, v0
  v_lshrrev_b32 v2, 6, v0
  s_nop 0
  v_readfirstlane_b32 s3, v2
  s_and_b32 s50, s2, 7
  s_sub_u32 s51, s2, 40
  s_lshr_b32 s51, s51, 3
  s_mul_i32 s51, s51, 1258
  s_mul_i32 s52, s3, 158
  s_add_u32 s51, s51, s52
  s_lshr_b32 s52, s50, 1
  s_lshl_b32 s52, s52, 7
  s_and_b32 s53, s50, 1
  s_lshl_b32 s53, s53, 10
  s_add_u32 s52, s52, s53
  v_lshrrev_b32 v20, 1, v1
  v_add_u32 v20, s51, v20
  v_lshlrev_b32 v20, 11, v20
  v_and_b32 v21, 1, v1
  v_lshl_add_u32 v20, v21, 9, v20
  v_add_u32 v20, s52, v20
  s_load_dwordx2 s[10:11], s[0:1], 48
  s_waitcnt lgkmcnt(0)
  s_mov_b32 s24, s10
  s_mov_b32 s25, s11
  s_mov_b32 s26, 393216
  s_mov_b32 s27, 0x20000
  s_sub_u32 s56, s2, 40
  s_lshr_b32 s56, s56, 3
  s_lshl_b32 s56, s56, 3
  s_add_u32 s56, s56, s3
  s_lshl_b32 s56, s56, 13
  v_lshlrev_b32 v22, 7, v1
  v_add_u32 v22, s56, v22
  buffer_load_dword v23, v22, s[24:27], 0 offen
  s_mov_b32 s16, s4
  s_mov_b32 s17, s5
  s_mov_b32 s18, 18022400
  s_mov_b32 s19, 0x20000
  s_waitcnt vmcnt(0)
  buffer_load_dword v24, v20, s[16:19], 0 offen
  v_add_u32 v20, 65536, v20
  buffer_load_dword v25, v20, s[16:19], 0 offen
  v_add_u32 v20, 65536, v20
  buffer_load_dword v26, v20, s[16:19], 0 offen
  v_add_u32 v20, 65536, v20
  buffer_load_dword v27, v20, s[16:19], 0 offen
  v_add_u32 v20, 65536, v20
  v_cmp_gt_u32 vcc, 60, v1
  s_nop 0
  s_and_saveexec_b64 s[54:55], vcc
  buffer_load_dword v28, v20, s[16:19], 0 offen
  v_add_u32 v20, 65536, v20
  s_endpgm
L_k1_mlp:
  s_load_dwordx2 s[4:5], s[0:1], 0
  s_load_dwordx4 s[8:11], s[0:1], 40
  s_load_dwordx2 s[6:7], s[0:1], 80
  v_and_b32 v1, 63, v0
  v_lshrrev_b32 v2, 6, v0
  s_nop 0
  v_readfirstlane_b32 s3, v2
  s_mov_b32 s47, s2
  s_sub_u32 s2, s2, 96
  s_mul_i32 s12, s2, 64
  s_lshr_b32 s14, s3, 1
  s_and_b32 s15, s3, 1
  s_lshl_b32 s13, s14, 7
  s_lshl_b32 s44, s14, 15
  s_add_u32 s44, s44, 32768
  s_lshl_b32 s48, s15, 11
  s_add_u32 s48, s44, s48
  v_lshrrev_b32 v3, 3, v1
  v_bfe_u32 v4, v1, 1, 2
  v_bfe_u32 v5, v1, 4, 1
  v_xor_b32 v4, v4, v5
  v_lshlrev_b32 v4, 5, v4
  v_and_b32 v5, 1, v1
  v_lshl_or_b32 v4, v5, 4, v4
  v_add_u32 v4, s13, v4
  s_lshl_b32 s49, s15, 4
  v_add_u32 v3, s49, v3
  v_lshl_add_u32 v6, v3, 9, v4
  v_xor_b32 v7, 64, v6
  v_mul_u32_u24 v8, 1536, v3
  v_add_u32 v8, v8, v4
  v_xor_b32 v9, 64, v8
  v_lshrrev_b32 v10, 5, v1
  s_mul_i32 s41, s3, 8
  v_add_u32 v10, s41, v10
  v_and_b32 v11, 31, v1
  s_mul_i32 s42, s3, 4096
  v_add_u32 v12, 0, v10
  v_and_b32 v13, 15, v12
  v_xor_b32 v13, v13, v11
  v_add_u32 v12, s12, v12
  v_lshlrev_b32 v12, 11, v12
  v_lshl_add_u32 v16, v13, 4, v12
  v_add_u32 v12, 2, v10
  v_and_b32 v13, 15, v12
  v_xor_b32 v13, v13, v11
  v_add_u32 v12, s12, v12
  v_lshlrev_b32 v12, 11, v12
  v_lshl_add_u32 v17, v13, 4, v12
  v_subrev_u32 v17, 1024, v17
  v_add_u32 v12, 4, v10
  v_and_b32 v13, 15, v12
  v_xor_b32 v13, v13, v11
  v_add_u32 v12, s12, v12
  v_lshlrev_b32 v12, 11, v12
  v_lshl_add_u32 v18, v13, 4, v12
  v_subrev_u32 v18, 2048, v18
  v_add_u32 v12, 6, v10
  v_and_b32 v13, 15, v12
  v_xor_b32 v13, v13, v11
  v_add_u32 v12, s12, v12
  v_lshlrev_b32 v12, 11, v12
  v_lshl_add_u32 v19, v13, 4, v12
  v_subrev_u32 v19, 3072, v19
  s_waitcnt lgkmcnt(0)
  s_mov_b32 s16, s4
  s_mov_b32 s17, s5
  s_mov_b32 s18, 20480000
  s_mov_b32 s19, 0x20000
  s_mov_b32 s20, s8
  s_mov_b32 s21, s9
  s_mov_b32 s22, 131072
  s_mov_b32 s23, 0x20000
  s_mov_b32 m0, s42
  s_nop 0
  buffer_load_dwordx4 v16, s[16:19], 0 offen offset:0  lds
  buffer_load_dwordx4 v17, s[16:19], 0 offen offset:1024  lds
  buffer_load_dwordx4 v18, s[16:19], 0 offen offset:2048  lds
  buffer_load_dwordx4 v19, s[16:19], 0 offen offset:3072  lds
  s_add_u32 m0, s48, 0
  s_mov_b32 s40, 0
  buffer_load_dwordx4 v6, s[20:23], s40 offen offset:0  lds
  s_mov_b32 s40, 3072
  buffer_load_dwordx4 v7, s[20:23], s40 offen offset:1024  lds
  s_add_u32 m0, s48, 4096
  s_mov_b32 s40, 16384
  buffer_load_dwordx4 v6, s[20:23], s40 offen offset:0  lds
  s_mov_b32 s40, 19456
  buffer_load_dwordx4 v7, s[20:23], s40 offen offset:1024  lds
  s_add_u32 m0, s48, 8192
  s_mov_b32 s40, 32768
  buffer_load_dwordx4 v6, s[20:23], s40 offen offset:0  lds
  s_mov_b32 s40, 35840
  buffer_load_dwordx4 v7, s[20:23], s40 offen offset:1024  lds
  s_add_u32 m0, s48, 12288
  s_mov_b32 s40, 49152
  buffer_load_dwordx4 v6, s[20:23], s40 offen offset:0  lds
  s_mov_b32 s40, 52224
  buffer_load_dwordx4 v7, s[20:23], s40 offen offset:1024  lds
  s_add_u32 m0, s48, 16384
  s_mov_b32 s40, 65536
  buffer_load_dwordx4 v6, s[20:23], s40 offen offset:0  lds
  s_mov_b32 s40, 68608
  buffer_load_dwordx4 v7, s[20:23], s40 offen offset:1024  lds
  s_add_u32 m0, s48, 20480
  s_mov_b32 s40, 81920
  buffer_load_dwordx4 v6, s[20:23], s40 offen offset:0  lds
  s_mov_b32 s40, 84992
  buffer_load_dwordx4 v7, s[20:23], s40 offen offset:1024  lds
  s_add_u32 m0, s48, 24576
  s_mov_b32 s40, 98304
  buffer_load_dwordx4 v6, s[20:23], s40 offen offset:0  lds
  s_mov_b32 s40, 101376
  buffer_load_dwordx4 v7, s[20:23], s40 offen offset:1024  lds
  s_add_u32 m0, s48, 28672
  s_mov_b32 s40, 114688
  buffer_load_dwordx4 v6, s[20:23], s40 offen offset:0  lds
  s_mov_b32 s40, 117760
  buffer_load_dwordx4 v7, s[20:23], s40 offen offset:1024  lds
  s_mov_b32 s24, s10
  s_mov_b32 s25, s11
  s_mov_b32 s26, 393216
  s_mov_b32 s27, 0x20000
  s_mov_b32 s28, s6
  s_mov_b32 s29, s7
  s_mov_b32 s30, 16777216
  s_mov_b32 s31, 0x20000
  v_and_b32 v3, 15, v1
  v_lshrrev_b32 v4, 4, v1
  v_lshrrev_b32 v5, 2, v3
  v_lshl_add_u32 v10, v4, 3, v5
  v_lshlrev_b32 v10, 7, v10
  v_lshrrev_b32 v11, 1, v5
  v_and_b32 v12, 1, v4
  v_lshl_or_b32 v11, v12, 1, v11
  s_lshl_b32 s49, s15, 1
  v_xor_b32 v11, s49, v11
  v_lshl_add_u32 v10, v11, 5, v10
  v_and_b32 v11, 3, v1
  v_lshl_add_u32 v10, v11, 3, v10
  v_add_u32 v10, s44, v10
  v_xor_b32 v11, 32, v10
  v_xor_b32 v14, v4, v3
  v_lshlrev_b32 v14, 4, v14
  v_lshl_add_u32 v24, v3, 9, v14
  v_xor_b32 v25, 64, v24
  v_xor_b32 v26, 128, v24
  v_xor_b32 v27, 192, v24
  v_lshrrev_b32 v5, 1, v4
  s_lshl_b32 s41, s3, 2
  v_add_u32 v5, s41, v5
  v_xor_b32 v5, v5, v3
  v_lshlrev_b32 v15, 4, v5
  v_lshl_add_u32 v15, v3, 9, v15
  v_and_b32 v5, 1, v4
  v_lshl_add_u32 v15, v5, 3, v15
  v_xor_b32 v16, 32, v15
  s_mul_i32 s43, s14, 8192
  v_lshrrev_b32 v5, 1, v4
  s_lshl_b32 s41, s15, 2
  v_add_u32 v5, s41, v5
  v_and_b32 v17, 7, v3
  v_xor_b32 v5, v5, v17
  v_lshlrev_b32 v17, 4, v5
  v_lshl_add_u32 v17, v3, 7, v17
  v_and_b32 v5, 1, v4
  v_lshl_add_u32 v17, v5, 3, v17
  v_add_u32 v17, s43, v17
  v_xor_b32 v18, 32, v17
  v_lshrrev_b32 v5, 3, v1
  v_and_b32 v19, 7, v1
  v_xor_b32 v19, v19, v5
  v_lshlrev_b32 v19, 4, v19
  v_lshl_add_u32 v19, v5, 7, v19
  s_mul_i32 s41, s15, 4096
  s_add_u32 s41, s41, s43
  v_add_u32 v19, s41, v19
  s_mul_i32 s41, s15, 32
  s_add_u32 s41, s41, s12
  v_add_u32 v23, s41, v5
  v_mul_u32_u24 v23, 1536, v23
  v_and_b32 v5, 7, v1
  v_lshl_add_u32 v23, v5, 4, v23
  v_add_u32 v23, s13, v23
  s_waitcnt vmcnt(16)
  s_waitcnt vmcnt(14)
  s_barrier
  ds_read_b128 v[28:31], v24 offset:0
  ds_read_b128 v[60:63], v24 offset:8192
  ds_read_b128 v[92:95], v24 offset:16384
  ds_read_b128 v[124:127], v24 offset:24576
  ds_read_b128 v[32:35], v25 offset:0
  ds_read_b128 v[64:67], v25 offset:8192
  ds_read_b128 v[96:99], v25 offset:16384
  ds_read_b128 v[128:131], v25 offset:24576
  ds_read_b64_tr_b16 v[156:157], v10 offset:0
  ds_read_b64_tr_b16 v[158:159], v10 offset:512
  ds_read_b64_tr_b16 v[160:161], v11 offset:0
  ds_read_b64_tr_b16 v[162:163], v11 offset:512
  s_waitcnt lgkmcnt(0)
  s_mov_b32 s45, 0
  s_waitcnt vmcnt(12)
  s_barrier
  v_mfma_f32_16x16x32_bf16 v[172:175], v[156:159], v[28:31], 0
  ds_read_b64_tr_b16 v[164:165], v10 offset:4096
  ds_read_b64_tr_b16 v[166:167], v10 offset:4608
  v_mfma_f32_16x16x32_bf16 v[176:179], v[156:159], v[60:63], 0
  ds_read_b64_tr_b16 v[168:169], v11 offset:4096
  ds_read_b64_tr_b16 v[170:171], v11 offset:4608
  v_mfma_f32_16x16x32_bf16 v[180:183], v[156:159], v[92:95], 0
  ds_read_b128 v[36:39], v26 offset:0
  ds_read_b128 v[68:71], v26 offset:8192
  v_mfma_f32_16x16x32_bf16 v[184:187], v[156:159], v[124:127], 0
  ds_read_b128 v[100:103], v26 offset:16384
  ds_read_b128 v[132:135], v26 offset:24576
  v_mfma_f32_16x16x32_bf16 v[188:191], v[160:163], v[28:31], 0
  s_add_u32 m0, s48, 0
  s_add_u32 s40, s45, 0
  v_mfma_f32_16x16x32_bf16 v[192:195], v[160:163], v[60:63], 0
  buffer_load_dwordx4 v8, s[24:27], s40 offen offset:0  lds
  s_add_u32 s40, s45, 11264
  v_mfma_f32_16x16x32_bf16 v[196:199], v[160:163], v[92:95], 0
  buffer_load_dwordx4 v9, s[24:27], s40 offen offset:1024  lds
  v_mfma_f32_16x16x32_bf16 v[200:203], v[160:163], v[124:127], 0
  s_waitcnt lgkmcnt(0)
  s_waitcnt vmcnt(12)
  s_barrier
  v_mfma_f32_16x16x32_bf16 v[172:175], v[164:167], v[32:35], v[172:175]
  ds_read_b64_tr_b16 v[156:157], v10 offset:8192
  ds_read_b64_tr_b16 v[158:159], v10 offset:8704
  v_mfma_f32_16x16x32_bf16 v[176:179], v[164:167], v[64:67], v[176:179]
  ds_read_b64_tr_b16 v[160:161], v11 offset:8192
  ds_read_b64_tr_b16 v[162:163], v11 offset:8704
  v_mfma_f32_16x16x32_bf16 v[180:183], v[164:167], v[96:99], v[180:183]
  ds_read_b128 v[40:43], v27 offset:0
  ds_read_b128 v[72:75], v27 offset:8192
  v_mfma_f32_16x16x32_bf16 v[184:187], v[164:167], v[128:131], v[184:187]
  ds_read_b128 v[104:107], v27 offset:16384
  ds_read_b128 v[136:139], v27 offset:24576
  v_mfma_f32_16x16x32_bf16 v[188:191], v[168:171], v[32:35], v[188:191]
  s_add_u32 m0, s48, 4096
  s_add_u32 s40, s45, 49152
  v_mfma_f32_16x16x32_bf16 v[192:195], v[168:171], v[64:67], v[192:195]
  buffer_load_dwordx4 v8, s[24:27], s40 offen offset:0  lds
  s_add_u32 s40, s45, 60416
  v_mfma_f32_16x16x32_bf16 v[196:199], v[168:171], v[96:99], v[196:199]
  buffer_load_dwordx4 v9, s[24:27], s40 offen offset:1024  lds
  v_mfma_f32_16x16x32_bf16 v[200:203], v[168:171], v[128:131], v[200:203]
  s_waitcnt lgkmcnt(0)
  s_waitcnt vmcnt(12)
  s_barrier
  v_mfma_f32_16x16x32_bf16 v[172:175], v[156:159], v[36:39], v[172:175]
  ds_read_b64_tr_b16 v[164:165], v10 offset:12288
  ds_read_b64_tr_b16 v[166:167], v10 offset:12800
  v_mfma_f32_16x16x32_bf16 v[176:179], v[156:159], v[68:71], v[176:179]
  ds_read_b64_tr_b16 v[168:169], v11 offset:12288
  ds_read_b64_tr_b16 v[170:171], v11 offset:12800
  v_mfma_f32_16x16x32_bf16 v[180:183], v[156:159], v[100:103], v[180:183]
  ds_read_b128 v[44:47], v24 offset:256
  ds_read_b128 v[76:79], v24 offset:8448
  v_mfma_f32_16x16x32_bf16 v[184:187], v[156:159], v[132:135], v[184:187]
  ds_read_b128 v[108:111], v24 offset:16640
  ds_read_b128 v[140:143], v24 offset:24832
  v_mfma_f32_16x16x32_bf16 v[188:191], v[160:163], v[36:39], v[188:191]
  s_add_u32 m0, s48, 8192
  s_add_u32 s40, s45, 98304
  v_mfma_f32_16x16x32_bf16 v[192:195], v[160:163], v[68:71], v[192:195]
  buffer_load_dwordx4 v8, s[24:27], s40 offen offset:0  lds
  s_add_u32 s40, s45, 109568
  v_mfma_f32_16x16x32_bf16 v[196:199], v[160:163], v[100:103], v[196:199]
  buffer_load_dwordx4 v9, s[24:27], s40 offen offset:1024  lds
  v_mfma_f32_16x16x32_bf16 v[200:203], v[160:163], v[132:135], v[200:203]
  s_waitcnt lgkmcnt(0)
  s_waitcnt vmcnt(12)
  s_barrier
  v_mfma_f32_16x16x32_bf16 v[172:175], v[164:167], v[40:43], v[172:175]
  ds_read_b64_tr_b16 v[156:157], v10 offset:16384
  ds_read_b64_tr_b16 v[158:159], v10 offset:16896
  v_mfma_f32_16x16x32_bf16 v[176:179], v[164:167], v[72:75], v[176:179]
  ds_read_b64_tr_b16 v[160:161], v11 offset:16384
  ds_read_b64_tr_b16 v[162:163], v11 offset:16896
  v_mfma_f32_16x16x32_bf16 v[180:183], v[164:167], v[104:107], v[180:183]
  ds_read_b128 v[48:51], v25 offset:256
  ds_read_b128 v[80:83], v25 offset:8448
  v_mfma_f32_16x16x32_bf16 v[184:187], v[164:167], v[136:139], v[184:187]
  ds_read_b128 v[112:115], v25 offset:16640
  ds_read_b128 v[144:147], v25 offset:24832
  v_mfma_f32_16x16x32_bf16 v[188:191], v[168:171], v[40:43], v[188:191]
  s_add_u32 m0, s48, 12288
  s_add_u32 s40, s45, 147456
  v_mfma_f32_16x16x32_bf16 v[192:195], v[168:171], v[72:75], v[192:195]
  buffer_load_dwordx4 v8, s[24:27], s40 offen offset:0  lds
  s_add_u32 s40, s45, 158720
  v_mfma_f32_16x16x32_bf16 v[196:199], v[168:171], v[104:107], v[196:199]
  buffer_load_dwordx4 v9, s[24:27], s40 offen offset:1024  lds
  v_mfma_f32_16x16x32_bf16 v[200:203], v[168:171], v[136:139], v[200:203]
  s_waitcnt lgkmcnt(0)
  s_waitcnt vmcnt(12)
  s_barrier
  v_mfma_f32_16x16x32_bf16 v[172:175], v[156:159], v[44:47], v[172:175]
  ds_read_b64_tr_b16 v[164:165], v10 offset:20480
  ds_read_b64_tr_b16 v[166:167], v10 offset:20992
  v_mfma_f32_16x16x32_bf16 v[176:179], v[156:159], v[76:79], v[176:179]
  ds_read_b64_tr_b16 v[168:169], v11 offset:20480
  ds_read_b64_tr_b16 v[170:171], v11 offset:20992
  v_mfma_f32_16x16x32_bf16 v[180:183], v[156:159], v[108:111], v[180:183]
  ds_read_b128 v[52:55], v26 offset:256
  ds_read_b128 v[84:87], v26 offset:8448
  v_mfma_f32_16x16x32_bf16 v[184:187], v[156:159], v[140:143], v[184:187]
  ds_read_b128 v[116:119], v26 offset:16640
  ds_read_b128 v[148:151], v26 offset:24832
  v_mfma_f32_16x16x32_bf16 v[188:191], v[160:163], v[44:47], v[188:191]
  s_add_u32 m0, s48, 16384
  s_add_u32 s40, s45, 196608
  v_mfma_f32_16x16x32_bf16 v[192:195], v[160:163], v[76:79], v[192:195]
  buffer_load_dwordx4 v8, s[24:27], s40 offen offset:0  lds
  s_add_u32 s40, s45, 207872
  v_mfma_f32_16x16x32_bf16 v[196:199], v[160:163], v[108:111], v[196:199]
  buffer_load_dwordx4 v9, s[24:27], s40 offen offset:1024  lds
  v_mfma_f32_16x16x32_bf16 v[200:203], v[160:163], v[140:143], v[200:203]
  s_waitcnt lgkmcnt(0)
  s_waitcnt vmcnt(12)
  s_barrier
  v_mfma_f32_16x16x32_bf16 v[172:175], v[164:167], v[48:51], v[172:175]
  ds_read_b64_tr_b16 v[156:157], v10 offset:24576
  ds_read_b64_tr_b16 v[158:159], v10 offset:25088
  v_mfma_f32_16x16x32_bf16 v[176:179], v[164:167], v[80:83], v[176:179]
  ds_read_b64_tr_b16 v[160:161], v11 offset:24576
  ds_read_b64_tr_b16 v[162:163], v11 offset:25088
  v_mfma_f32_16x16x32_bf16 v[180:183], v[164:167], v[112:115], v[180:183]
  ds_read_b128 v[56:59], v27 offset:256
  ds_read_b128 v[88:91], v27 offset:8448
  v_mfma_f32_16x16x32_bf16 v[184:187], v[164:167], v[144:147], v[184:187]
  ds_read_b128 v[120:123], v27 offset:16640
  ds_read_b128 v[152:155], v27 offset:24832
  v_mfma_f32_16x16x32_bf16 v[188:191], v[168:171], v[48:51], v[188:191]
  s_add_u32 m0, s48, 20480
  s_add_u32 s40, s45, 245760
  v_mfma_f32_16x16x32_bf16 v[192:195], v[168:171], v[80:83], v[192:195]
  buffer_load_dwordx4 v8, s[24:27], s40 offen offset:0  lds
  s_add_u32 s40, s45, 257024
  v_mfma_f32_16x16x32_bf16 v[196:199], v[168:171], v[112:115], v[196:199]
  buffer_load_dwordx4 v9, s[24:27], s40 offen offset:1024  lds
  v_mfma_f32_16x16x32_bf16 v[200:203], v[168:171], v[144:147], v[200:203]
  s_waitcnt lgkmcnt(0)
  s_waitcnt vmcnt(12)
  s_barrier
  v_mfma_f32_16x16x32_bf16 v[172:175], v[156:159], v[52:55], v[172:175]
  ds_read_b64_tr_b16 v[164:165], v10 offset:28672
  ds_read_b64_tr_b16 v[166:167], v10 offset:29184
  v_mfma_f32_16x16x32_bf16 v[176:179], v[156:159], v[84:87], v[176:179]
  ds_read_b64_tr_b16 v[168:169], v11 offset:28672
  ds_read_b64_tr_b16 v[170:171], v11 offset:29184
  v_mfma_f32_16x16x32_bf16 v[180:183], v[156:159], v[116:119], v[180:183]
  s_add_u32 m0, s48, 24576
  s_add_u32 s40, s45, 294912
  v_mfma_f32_16x16x32_bf16 v[184:187], v[156:159], v[148:151], v[184:187]
  buffer_load_dwordx4 v8, s[24:27], s40 offen offset:0  lds
  s_add_u32 s40, s45, 306176
  v_mfma_f32_16x16x32_bf16 v[188:191], v[160:163], v[52:55], v[188:191]
  buffer_load_dwordx4 v9, s[24:27], s40 offen offset:1024  lds
  v_mfma_f32_16x16x32_bf16 v[192:195], v[160:163], v[84:87], v[192:195]
  v_mfma_f32_16x16x32_bf16 v[196:199], v[160:163], v[116:119], v[196:199]
  v_mfma_f32_16x16x32_bf16 v[200:203], v[160:163], v[148:151], v[200:203]
  s_waitcnt lgkmcnt(0)
  s_waitcnt vmcnt(12)
  s_barrier
  v_mfma_f32_16x16x32_bf16 v[172:175], v[164:167], v[56:59], v[172:175]
  ds_read_b64_tr_b16 v[156:157], v10 offset:0
  ds_read_b64_tr_b16 v[158:159], v10 offset:512
  v_mfma_f32_16x16x32_bf16 v[176:179], v[164:167], v[88:91], v[176:179]
  ds_read_b64_tr_b16 v[160:161], v11 offset:0
  ds_read_b64_tr_b16 v[162:163], v11 offset:512
  v_mfma_f32_16x16x32_bf16 v[180:183], v[164:167], v[120:123], v[180:183]
  s_add_u32 m0, s48, 28672
  s_add_u32 s40, s45, 344064
  v_mfma_f32_16x16x32_bf16 v[184:187], v[164:167], v[152:155], v[184:187]
  buffer_load_dwordx4 v8, s[24:27], s40 offen offset:0  lds
  s_add_u32 s40, s45, 355328
  v_mfma_f32_16x16x32_bf16 v[188:191], v[168:171], v[56:59], v[188:191]
  buffer_load_dwordx4 v9, s[24:27], s40 offen offset:1024  lds
  v_mfma_f32_16x16x32_bf16 v[192:195], v[168:171], v[88:91], v[192:195]
  v_mfma_f32_16x16x32_bf16 v[196:199], v[168:171], v[120:123], v[196:199]
  v_mfma_f32_16x16x32_bf16 v[200:203], v[168:171], v[152:155], v[200:203]
  s_waitcnt lgkmcnt(0)
  s_mov_b32 s41, 0xbfb8aa3b
  v_mov_b32 v22, s41
  v_mul_f32 v204, v22, v172
  v_mul_f32 v205, v22, v173
  v_mul_f32 v206, v22, v174
  v_mul_f32 v207, v22, v175
  v_exp_f32 v204, v204
  v_exp_f32 v205, v205
  v_exp_f32 v206, v206
  v_exp_f32 v207, v207
  v_add_f32 v204, 1.0, v204
  v_add_f32 v205, 1.0, v205
  v_add_f32 v206, 1.0, v206
  v_add_f32 v207, 1.0, v207
  v_rcp_f32 v204, v204
  v_rcp_f32 v205, v205
  v_rcp_f32 v206, v206
  v_rcp_f32 v207, v207
  v_mul_f32 v172, v172, v204
  v_mul_f32 v173, v173, v205
  v_mul_f32 v174, v174, v206
  v_mul_f32 v175, v175, v207
  v_cvt_pk_bf16_f32 v172, v172, v173
  v_cvt_pk_bf16_f32 v173, v174, v175
  ds_write_b64 v15, v[172:173] offset:0
  v_mul_f32 v208, v22, v176
  v_mul_f32 v209, v22, v177
  v_mul_f32 v210, v22, v178
  v_mul_f32 v211, v22, v179
  v_exp_f32 v208, v208
  v_exp_f32 v209, v209
  v_exp_f32 v210, v210
  v_exp_f32 v211, v211
  v_add_f32 v208, 1.0, v208
  v_add_f32 v209, 1.0, v209
  v_add_f32 v210, 1.0, v210
  v_add_f32 v211, 1.0, v211
  v_rcp_f32 v208, v208
  v_rcp_f32 v209, v209
  v_rcp_f32 v210, v210
  v_rcp_f32 v211, v211
  v_mul_f32 v176, v176, v208
  v_mul_f32 v177, v177, v209
  v_mul_f32 v178, v178, v210
  v_mul_f32 v179, v179, v211
  v_cvt_pk_bf16_f32 v176, v176, v177
  v_cvt_pk_bf16_f32 v177, v178, v179
  ds_write_b64 v15, v[176:177] offset:8192
  v_mul_f32 v204, v22, v180
  v_mul_f32 v205, v22, v181
  v_mul_f32 v206, v22, v182
  v_mul_f32 v207, v22, v183
  v_exp_f32 v204, v204
  v_exp_f32 v205, v205
  v_exp_f32 v206, v206
  v_exp_f32 v207, v207
  v_add_f32 v204, 1.0, v204
  v_add_f32 v205, 1.0, v205
  v_add_f32 v206, 1.0, v206
  v_add_f32 v207, 1.0, v207
  v_rcp_f32 v204, v204
  v_rcp_f32 v205, v205
  v_rcp_f32 v206, v206
  v_rcp_f32 v207, v207
  v_mul_f32 v180, v180, v204
  v_mul_f32 v181, v181, v205
  v_mul_f32 v182, v182, v206
  v_mul_f32 v183, v183, v207
  v_cvt_pk_bf16_f32 v180, v180, v181
  v_cvt_pk_bf16_f32 v181, v182, v183
  ds_write_b64 v15, v[180:181] offset:16384
  v_mul_f32 v208, v22, v184
  v_mul_f32 v209, v22, v185
  v_mul_f32 v210, v22, v186
  v_mul_f32 v211, v22, v187
  v_exp_f32 v208, v208
  v_exp_f32 v209, v209
  v_exp_f32 v210, v210
  v_exp_f32 v211, v211
  v_add_f32 v208, 1.0, v208
  v_add_f32 v209, 1.0, v209
  v_add_f32 v210, 1.0, v210
  v_add_f32 v211, 1.0, v211
  v_rcp_f32 v208, v208
  v_rcp_f32 v209, v209
  v_rcp_f32 v210, v210
  v_rcp_f32 v211, v211
  v_mul_f32 v184, v184, v208
  v_mul_f32 v185, v185, v209
  v_mul_f32 v186, v186, v210
  v_mul_f32 v187, v187, v211
  v_cvt_pk_bf16_f32 v184, v184, v185
  v_cvt_pk_bf16_f32 v185, v186, v187
  ds_write_b64 v15, v[184:185] offset:24576
  v_mul_f32 v204, v22, v188
  v_mul_f32 v205, v22, v189
  v_mul_f32 v206, v22, v190
  v_mul_f32 v207, v22, v191
  v_exp_f32 v204, v204
  v_exp_f32 v205, v205
  v_exp_f32 v206, v206
  v_exp_f32 v207, v207
  v_add_f32 v204, 1.0, v204
  v_add_f32 v205, 1.0, v205
  v_add_f32 v206, 1.0, v206
  v_add_f32 v207, 1.0, v207
  v_rcp_f32 v204, v204
  v_rcp_f32 v205, v205
  v_rcp_f32 v206, v206
  v_rcp_f32 v207, v207
  v_mul_f32 v188, v188, v204
  v_mul_f32 v189, v189, v205
  v_mul_f32 v190, v190, v206
  v_mul_f32 v191, v191, v207
  v_cvt_pk_bf16_f32 v188, v188, v189
  v_cvt_pk_bf16_f32 v189, v190, v191
  ds_write_b64 v16, v[188:189] offset:0
  v_mul_f32 v208, v22, v192
  v_mul_f32 v209, v22, v193
  v_mul_f32 v210, v22, v194
  v_mul_f32 v211, v22, v195
  v_exp_f32 v208, v208
  v_exp_f32 v209, v209
  v_exp_f32 v210, v210
  v_exp_f32 v211, v211
  v_add_f32 v208, 1.0, v208
  v_add_f32 v209, 1.0, v209
  v_add_f32 v210, 1.0, v210
  v_add_f32 v211, 1.0, v211
  v_rcp_f32 v208, v208
  v_rcp_f32 v209, v209
  v_rcp_f32 v210, v210
  v_rcp_f32 v211, v211
  v_mul_f32 v192, v192, v208
  v_mul_f32 v193, v193, v209
  v_mul_f32 v194, v194, v210
  v_mul_f32 v195, v195, v211
  v_cvt_pk_bf16_f32 v192, v192, v193
  v_cvt_pk_bf16_f32 v193, v194, v195
  ds_write_b64 v16, v[192:193] offset:8192
  v_mul_f32 v204, v22, v196
  v_mul_f32 v205, v22, v197
  v_mul_f32 v206, v22, v198
  v_mul_f32 v207, v22, v199
  v_exp_f32 v204, v204
  v_exp_f32 v205, v205
  v_exp_f32 v206, v206
  v_exp_f32 v207, v207
  v_add_f32 v204, 1.0, v204
  v_add_f32 v205, 1.0, v205
  v_add_f32 v206, 1.0, v206
  v_add_f32 v207, 1.0, v207
  v_rcp_f32 v204, v204
  v_rcp_f32 v205, v205
  v_rcp_f32 v206, v206
  v_rcp_f32 v207, v207
  v_mul_f32 v196, v196, v204
  v_mul_f32 v197, v197, v205
  v_mul_f32 v198, v198, v206
  v_mul_f32 v199, v199, v207
  v_cvt_pk_bf16_f32 v196, v196, v197
  v_cvt_pk_bf16_f32 v197, v198, v199
  ds_write_b64 v16, v[196:197] offset:16384
  v_mul_f32 v208, v22, v200
  v_mul_f32 v209, v22, v201
  v_mul_f32 v210, v22, v202
  v_mul_f32 v211, v22, v203
  v_exp_f32 v208, v208
  v_exp_f32 v209, v209
  v_exp_f32 v210, v210
  v_exp_f32 v211, v211
  v_add_f32 v208, 1.0, v208
  v_add_f32 v209, 1.0, v209
  v_add_f32 v210, 1.0, v210
  v_add_f32 v211, 1.0, v211
  v_rcp_f32 v208, v208
  v_rcp_f32 v209, v209
  v_rcp_f32 v210, v210
  v_rcp_f32 v211, v211
  v_mul_f32 v200, v200, v208
  v_mul_f32 v201, v201, v209
  v_mul_f32 v202, v202, v210
  v_mul_f32 v203, v203, v211
  v_cvt_pk_bf16_f32 v200, v200, v201
  v_cvt_pk_bf16_f32 v201, v202, v203
  ds_write_b64 v16, v[200:201] offset:24576
  s_waitcnt lgkmcnt(0)
  s_barrier
  ds_read_b128 v[28:31], v24 offset:0
  ds_read_b128 v[60:63], v24 offset:8192
  ds_read_b128 v[92:95], v24 offset:16384
  ds_read_b128 v[124:127], v24 offset:24576
  ds_read_b128 v[32:35], v25 offset:0
  ds_read_b128 v[64:67], v25 offset:8192
  ds_read_b128 v[96:99], v25 offset:16384
  ds_read_b128 v[128:131], v25 offset:24576
  s_waitcnt lgkmcnt(0)
  s_mov_b32 s45, 512
  s_waitcnt vmcnt(12)
  s_barrier
  v_mfma_f32_16x16x32_bf16 v[172:175], v[156:159], v[28:31], 0
  ds_read_b64_tr_b16 v[164:165], v10 offset:4096
  ds_read_b64_tr_b16 v[166:167], v10 offset:4608
  v_mfma_f32_16x16x32_bf16 v[176:179], v[156:159], v[60:63], 0
  ds_read_b64_tr_b16 v[168:169], v11 offset:4096
  ds_read_b64_tr_b16 v[170:171], v11 offset:4608
  v_mfma_f32_16x16x32_bf16 v[180:183], v[156:159], v[92:95], 0
  ds_read_b128 v[36:39], v26 offset:0
  ds_read_b128 v[68:71], v26 offset:8192
  v_mfma_f32_16x16x32_bf16 v[184:187], v[156:159], v[124:127], 0
  ds_read_b128 v[100:103], v26 offset:16384
  ds_read_b128 v[132:135], v26 offset:24576
  v_mfma_f32_16x16x32_bf16 v[188:191], v[160:163], v[28:31], 0
  s_add_u32 m0, s48, 0
  s_add_u32 s40, s45, 0
  v_mfma_f32_16x16x32_bf16 v[192:195], v[160:163], v[60:63], 0
  buffer_load_dwordx4 v8, s[24:27], s40 offen offset:0  lds
  s_add_u32 s40, s45, 11264
  v_mfma_f32_16x16x32_bf16 v[196:199], v[160:163], v[92:95], 0
  buffer_load_dwordx4 v9, s[24:27], s40 offen offset:1024  lds
  v_mfma_f32_16x16x32_bf16 v[200:203], v[160:163], v[124:127], 0
  s_waitcnt lgkmcnt(0)
  s_waitcnt vmcnt(12)
  s_barrier
  v_mfma_f32_16x16x32_bf16 v[172:175], v[164:167], v[32:35], v[172:175]
  ds_read_b64_tr_b16 v[156:157], v10 offset:8192
  ds_read_b64_tr_b16 v[158:159], v10 offset:8704
  v_mfma_f32_16x16x32_bf16 v[176:179], v[164:167], v[64:67], v[176:179]
  ds_read_b64_tr_b16 v[160:161], v11 offset:8192
  ds_read_b64_tr_b16 v[162:163], v11 offset:8704
  v_mfma_f32_16x16x32_bf16 v[180:183], v[164:167], v[96:99], v[180:183]
  ds_read_b128 v[40:43], v27 offset:0
  ds_read_b128 v[72:75], v27 offset:8192
  v_mfma_f32_16x16x32_bf16 v[184:187], v[164:167], v[128:131], v[184:187]
  ds_read_b128 v[104:107], v27 offset:16384
  ds_read_b128 v[136:139], v27 offset:24576
  v_mfma_f32_16x16x32_bf16 v[188:191], v[168:171], v[32:35], v[188:191]
  s_add_u32 m0, s48, 4096
  s_add_u32 s40, s45, 49152
  v_mfma_f32_16x16x32_bf16 v[192:195], v[168:171], v[64:67], v[192:195]
  buffer_load_dwordx4 v8, s[24:27], s40 offen offset:0  lds
  s_add_u32 s40, s45, 60416
  v_mfma_f32_16x16x32_bf16 v[196:199], v[168:171], v[96:99], v[196:199]
  buffer_load_dwordx4 v9, s[24:27], s40 offen offset:1024  lds
  v_mfma_f32_16x16x32_bf16 v[200:203], v[168:171], v[128:131], v[200:203]
  s_waitcnt lgkmcnt(0)
  s_waitcnt vmcnt(12)
  s_barrier
  v_mfma_f32_16x16x32_bf16 v[172:175], v[156:159], v[36:39], v[172:175]
  ds_read_b64_tr_b16 v[164:165], v10 offset:12288
  ds_read_b64_tr_b16 v[166:167], v10 offset:12800
  v_mfma_f32_16x16x32_bf16 v[176:179], v[156:159], v[68:71], v[176:179]
  ds_read_b64_tr_b16 v[168:169], v11 offset:12288
  ds_read_b64_tr_b16 v[170:171], v11 offset:12800
  v_mfma_f32_16x16x32_bf16 v[180:183], v[156:159], v[100:103], v[180:183]
  ds_read_b128 v[44:47], v24 offset:256
  ds_read_b128 v[76:79], v24 offset:8448
  v_mfma_f32_16x16x32_bf16 v[184:187], v[156:159], v[132:135], v[184:187]
  ds_read_b128 v[108:111], v24 offset:16640
  ds_read_b128 v[140:143], v24 offset:24832
  v_mfma_f32_16x16x32_bf16 v[188:191], v[160:163], v[36:39], v[188:191]
  s_add_u32 m0, s48, 8192
  s_add_u32 s40, s45, 98304
  v_mfma_f32_16x16x32_bf16 v[192:195], v[160:163], v[68:71], v[192:195]
  buffer_load_dwordx4 v8, s[24:27], s40 offen offset:0  lds
  s_add_u32 s40, s45, 109568
  v_mfma_f32_16x16x32_bf16 v[196:199], v[160:163], v[100:103], v[196:199]
  buffer_load_dwordx4 v9, s[24:27], s40 offen offset:1024  lds
  v_mfma_f32_16x16x32_bf16 v[200:203], v[160:163], v[132:135], v[200:203]
  s_waitcnt lgkmcnt(0)
  s_waitcnt vmcnt(12)
  s_barrier
  v_mfma_f32_16x16x32_bf16 v[172:175], v[164:167], v[40:43], v[172:175]
  ds_read_b64_tr_b16 v[156:157], v10 offset:16384
  ds_read_b64_tr_b16 v[158:159], v10 offset:16896
  v_mfma_f32_16x16x32_bf16 v[176:179], v[164:167], v[72:75], v[176:179]
  ds_read_b64_tr_b16 v[160:161], v11 offset:16384
  ds_read_b64_tr_b16 v[162:163], v11 offset:16896
  v_mfma_f32_16x16x32_bf16 v[180:183], v[164:167], v[104:107], v[180:183]
  ds_read_b128 v[48:51], v25 offset:256
  ds_read_b128 v[80:83], v25 offset:8448
  v_mfma_f32_16x16x32_bf16 v[184:187], v[164:167], v[136:139], v[184:187]
  ds_read_b128 v[112:115], v25 offset:16640
  ds_read_b128 v[144:147], v25 offset:24832
  v_mfma_f32_16x16x32_bf16 v[188:191], v[168:171], v[40:43], v[188:191]
  s_add_u32 m0, s48, 12288
  s_add_u32 s40, s45, 147456
  v_mfma_f32_16x16x32_bf16 v[192:195], v[168:171], v[72:75], v[192:195]
  buffer_load_dwordx4 v8, s[24:27], s40 offen offset:0  lds
  s_add_u32 s40, s45, 158720
  v_mfma_f32_16x16x32_bf16 v[196:199], v[168:171], v[104:107], v[196:199]
  buffer_load_dwordx4 v9, s[24:27], s40 offen offset:1024  lds
  v_mfma_f32_16x16x32_bf16 v[200:203], v[168:171], v[136:139], v[200:203]
  s_waitcnt lgkmcnt(0)
  s_waitcnt vmcnt(12)
  s_barrier
  v_mfma_f32_16x16x32_bf16 v[172:175], v[156:159], v[44:47], v[172:175]
  ds_read_b64_tr_b16 v[164:165], v10 offset:20480
  ds_read_b64_tr_b16 v[166:167], v10 offset:20992
  v_mfma_f32_16x16x32_bf16 v[176:179], v[156:159], v[76:79], v[176:179]
  ds_read_b64_tr_b16 v[168:169], v11 offset:20480
  ds_read_b64_tr_b16 v[170:171], v11 offset:20992
  v_mfma_f32_16x16x32_bf16 v[180:183], v[156:159], v[108:111], v[180:183]
  ds_read_b128 v[52:55], v26 offset:256
  ds_read_b128 v[84:87], v26 offset:8448
  v_mfma_f32_16x16x32_bf16 v[184:187], v[156:159], v[140:143], v[184:187]
  ds_read_b128 v[116:119], v26 offset:16640
  ds_read_b128 v[148:151], v26 offset:24832
  v_mfma_f32_16x16x32_bf16 v[188:191], v[160:163], v[44:47], v[188:191]
  s_add_u32 m0, s48, 16384
  s_add_u32 s40, s45, 196608
  v_mfma_f32_16x16x32_bf16 v[192:195], v[160:163], v[76:79], v[192:195]
  buffer_load_dwordx4 v8, s[24:27], s40 offen offset:0  lds
  s_add_u32 s40, s45, 207872
  v_mfma_f32_16x16x32_bf16 v[196:199], v[160:163], v[108:111], v[196:199]
  buffer_load_dwordx4 v9, s[24:27], s40 offen offset:1024  lds
  v_mfma_f32_16x16x32_bf16 v[200:203], v[160:163], v[140:143], v[200:203]
  s_waitcnt lgkmcnt(0)
  s_waitcnt vmcnt(12)
  s_barrier
  v_mfma_f32_16x16x32_bf16 v[172:175], v[164:167], v[48:51], v[172:175]
  ds_read_b64_tr_b16 v[156:157], v10 offset:24576
  ds_read_b64_tr_b16 v[158:159], v10 offset:25088
  v_mfma_f32_16x16x32_bf16 v[176:179], v[164:167], v[80:83], v[176:179]
  ds_read_b64_tr_b16 v[160:161], v11 offset:24576
  ds_read_b64_tr_b16 v[162:163], v11 offset:25088
  v_mfma_f32_16x16x32_bf16 v[180:183], v[164:167], v[112:115], v[180:183]
  ds_read_b128 v[56:59], v27 offset:256
  ds_read_b128 v[88:91], v27 offset:8448
  v_mfma_f32_16x16x32_bf16 v[184:187], v[164:167], v[144:147], v[184:187]
  ds_read_b128 v[120:123], v27 offset:16640
  ds_read_b128 v[152:155], v27 offset:24832
  v_mfma_f32_16x16x32_bf16 v[188:191], v[168:171], v[48:51], v[188:191]
  s_add_u32 m0, s48, 20480
  s_add_u32 s40, s45, 245760
  v_mfma_f32_16x16x32_bf16 v[192:195], v[168:171], v[80:83], v[192:195]
  buffer_load_dwordx4 v8, s[24:27], s40 offen offset:0  lds
  s_add_u32 s40, s45, 257024
  v_mfma_f32_16x16x32_bf16 v[196:199], v[168:171], v[112:115], v[196:199]
  buffer_load_dwordx4 v9, s[24:27], s40 offen offset:1024  lds
  v_mfma_f32_16x16x32_bf16 v[200:203], v[168:171], v[144:147], v[200:203]
  s_waitcnt lgkmcnt(0)
  s_waitcnt vmcnt(12)
  s_barrier
  v_mfma_f32_16x16x32_bf16 v[172:175], v[156:159], v[52:55], v[172:175]
  ds_read_b64_tr_b16 v[164:165], v10 offset:28672
  ds_read_b64_tr_b16 v[166:167], v10 offset:29184
  v_mfma_f32_16x16x32_bf16 v[176:179], v[156:159], v[84:87], v[176:179]
  ds_read_b64_tr_b16 v[168:169], v11 offset:28672
  ds_read_b64_tr_b16 v[170:171], v11 offset:29184
  v_mfma_f32_16x16x32_bf16 v[180:183], v[156:159], v[116:119], v[180:183]
  s_add_u32 m0, s48, 24576
  s_add_u32 s40, s45, 294912
  v_mfma_f32_16x16x32_bf16 v[184:187], v[156:159], v[148:151], v[184:187]
  buffer_load_dwordx4 v8, s[24:27], s40 offen offset:0  lds
  s_add_u32 s40, s45, 306176
  v_mfma_f32_16x16x32_bf16 v[188:191], v[160:163], v[52:55], v[188:191]
  buffer_load_dwordx4 v9, s[24:27], s40 offen offset:1024  lds
  v_mfma_f32_16x16x32_bf16 v[192:195], v[160:163], v[84:87], v[192:195]
  v_mfma_f32_16x16x32_bf16 v[196:199], v[160:163], v[116:119], v[196:199]
  v_mfma_f32_16x16x32_bf16 v[200:203], v[160:163], v[148:151], v[200:203]
  s_waitcnt lgkmcnt(0)
  s_waitcnt vmcnt(12)
  s_barrier
  v_mfma_f32_16x16x32_bf16 v[172:175], v[164:167], v[56:59], v[172:175]
  ds_read_b64_tr_b16 v[156:157], v10 offset:0
  ds_read_b64_tr_b16 v[158:159], v10 offset:512
  v_mfma_f32_16x16x32_bf16 v[176:179], v[164:167], v[88:91], v[176:179]
  ds_read_b64_tr_b16 v[160:161], v11 offset:0
  ds_read_b64_tr_b16 v[162:163], v11 offset:512
  v_mfma_f32_16x16x32_bf16 v[180:183], v[164:167], v[120:123], v[180:183]
  s_add_u32 m0, s48, 28672
  s_add_u32 s40, s45, 344064
  v_mfma_f32_16x16x32_bf16 v[184:187], v[164:167], v[152:155], v[184:187]
  buffer_load_dwordx4 v8, s[24:27], s40 offen offset:0  lds
  s_add_u32 s40, s45, 355328
  v_mfma_f32_16x16x32_bf16 v[188:191], v[168:171], v[56:59], v[188:191]
  buffer_load_dwordx4 v9, s[24:27], s40 offen offset:1024  lds
  v_mfma_f32_16x16x32_bf16 v[192:195], v[168:171], v[88:91], v[192:195]
  v_mfma_f32_16x16x32_bf16 v[196:199], v[168:171], v[120:123], v[196:199]
  v_mfma_f32_16x16x32_bf16 v[200:203], v[168:171], v[152:155], v[200:203]
  s_waitcnt lgkmcnt(0)
  s_mov_b32 s46, 0
  v_cvt_pk_bf16_f32 v172, v172, v173
  v_cvt_pk_bf16_f32 v173, v174, v175
  ds_write_b64 v17, v[172:173] offset:0
  v_cvt_pk_bf16_f32 v176, v176, v177
  v_cvt_pk_bf16_f32 v177, v178, v179
  ds_write_b64 v17, v[176:177] offset:2048
  v_cvt_pk_bf16_f32 v180, v180, v181
  v_cvt_pk_bf16_f32 v181, v182, v183
  ds_write_b64 v17, v[180:181] offset:4096
  v_cvt_pk_bf16_f32 v184, v184, v185
  v_cvt_pk_bf16_f32 v185, v186, v187
  ds_write_b64 v17, v[184:185] offset:6144
  v_cvt_pk_bf16_f32 v188, v188, v189
  v_cvt_pk_bf16_f32 v189, v190, v191
  ds_write_b64 v18, v[188:189] offset:0
  v_cvt_pk_bf16_f32 v192, v192, v193
  v_cvt_pk_bf16_f32 v193, v194, v195
  ds_write_b64 v18, v[192:193] offset:2048
  v_cvt_pk_bf16_f32 v196, v196, v197
  v_cvt_pk_bf16_f32 v197, v198, v199
  ds_write_b64 v18, v[196:197] offset:4096
  v_cvt_pk_bf16_f32 v200, v200, v201
  v_cvt_pk_bf16_f32 v201, v202, v203
  ds_write_b64 v18, v[200:201] offset:6144
  s_waitcnt lgkmcnt(0)
  s_barrier
  ds_read_b128 v[204:207], v19 offset:0
  ds_read_b128 v[208:211], v19 offset:1024
  ds_read_b128 v[212:215], v19 offset:2048
  ds_read_b128 v[216:219], v19 offset:3072
  s_waitcnt lgkmcnt(3)
  s_add_u32 s40, s46, 0
  buffer_store_dwordx4 v[204:207], v23, s[28:31], s40 offen sc0 sc1
  s_waitcnt lgkmcnt(2)
  s_add_u32 s40, s46, 12288
  buffer_store_dwordx4 v[208:211], v23, s[28:31], s40 offen sc0 sc1
  s_waitcnt lgkmcnt(1)
  s_add_u32 s40, s46, 24576
  buffer_store_dwordx4 v[212:215], v23, s[28:31], s40 offen sc0 sc1
  s_waitcnt lgkmcnt(0)
  s_add_u32 s40, s46, 36864
  buffer_store_dwordx4 v[216:219], v23, s[28:31], s40 offen sc0 sc1
  s_mov_b32 s45, 1024
  s_waitcnt vmcnt(16)
  s_barrier
  v_mfma_f32_16x16x32_bf16 v[172:175], v[156:159], v[28:31], 0
  ds_read_b64_tr_b16 v[164:165], v10 offset:4096
  ds_read_b64_tr_b16 v[166:167], v10 offset:4608
  v_mfma_f32_16x16x32_bf16 v[176:179], v[156:159], v[60:63], 0
  ds_read_b64_tr_b16 v[168:169], v11 offset:4096
  ds_read_b64_tr_b16 v[170:171], v11 offset:4608
  v_mfma_f32_16x16x32_bf16 v[180:183], v[156:159], v[92:95], 0
  s_add_u32 m0, s48, 0
  s_add_u32 s40, s45, 0
  v_mfma_f32_16x16x32_bf16 v[184:187], v[156:159], v[124:127], 0
  buffer_load_dwordx4 v8, s[24:27], s40 offen offset:0  lds
  s_add_u32 s40, s45, 11264
  v_mfma_f32_16x16x32_bf16 v[188:191], v[160:163], v[28:31], 0
  buffer_load_dwordx4 v9, s[24:27], s40 offen offset:1024  lds
  v_mfma_f32_16x16x32_bf16 v[192:195], v[160:163], v[60:63], 0
  v_mfma_f32_16x16x32_bf16 v[196:199], v[160:163], v[92:95], 0
  v_mfma_f32_16x16x32_bf16 v[200:203], v[160:163], v[124:127], 0
  s_waitcnt lgkmcnt(0)
  s_waitcnt vmcnt(16)
  s_barrier
  v_mfma_f32_16x16x32_bf16 v[172:175], v[164:167], v[32:35], v[172:175]
  ds_read_b64_tr_b16 v[156:157], v10 offset:8192
  ds_read_b64_tr_b16 v[158:159], v10 offset:8704
  v_mfma_f32_16x16x32_bf16 v[176:179], v[164:167], v[64:67], v[176:179]
  ds_read_b64_tr_b16 v[160:161], v11 offset:8192
  ds_read_b64_tr_b16 v[162:163], v11 offset:8704
  v_mfma_f32_16x16x32_bf16 v[180:183], v[164:167], v[96:99], v[180:183]
  s_add_u32 m0, s48, 4096
  s_add_u32 s40, s45, 49152
  v_mfma_f32_16x16x32_bf16 v[184:187], v[164:167], v[128:131], v[184:187]
  buffer_load_dwordx4 v8, s[24:27], s40 offen offset:0  lds
  s_add_u32 s40, s45, 60416
  v_mfma_f32_16x16x32_bf16 v[188:191], v[168:171], v[32:35], v[188:191]
  buffer_load_dwordx4 v9, s[24:27], s40 offen offset:1024  lds
  v_mfma_f32_16x16x32_bf16 v[192:195], v[168:171], v[64:67], v[192:195]
  v_mfma_f32_16x16x32_bf16 v[196:199], v[168:171], v[96:99], v[196:199]
  v_mfma_f32_16x16x32_bf16 v[200:203], v[168:171], v[128:131], v[200:203]
  s_waitcnt lgkmcnt(0)
  s_waitcnt vmcnt(16)
  s_barrier
  v_mfma_f32_16x16x32_bf16 v[172:175], v[156:159], v[36:39], v[172:175]
  ds_read_b64_tr_b16 v[164:165], v10 offset:12288
  ds_read_b64_tr_b16 v[166:167], v10 offset:12800
  v_mfma_f32_16x16x32_bf16 v[176:179], v[156:159], v[68:71], v[176:179]
  ds_read_b64_tr_b16 v[168:169], v11 offset:12288
  ds_read_b64_tr_b16 v[170:171], v11 offset:12800
  v_mfma_f32_16x16x32_bf16 v[180:183], v[156:159], v[100:103], v[180:183]
  s_add_u32 m0, s48, 8192
  s_add_u32 s40, s45, 98304
  v_mfma_f32_16x16x32_bf16 v[184:187], v[156:159], v[132:135], v[184:187]
  buffer_load_dwordx4 v8, s[24:27], s40 offen offset:0  lds
  s_add_u32 s40, s45, 109568
  v_mfma_f32_16x16x32_bf16 v[188:191], v[160:163], v[36:39], v[188:191]
  buffer_load_dwordx4 v9, s[24:27], s40 offen offset:1024  lds
  v_mfma_f32_16x16x32_bf16 v[192:195], v[160:163], v[68:71], v[192:195]
  v_mfma_f32_16x16x32_bf16 v[196:199], v[160:163], v[100:103], v[196:199]
  v_mfma_f32_16x16x32_bf16 v[200:203], v[160:163], v[132:135], v[200:203]
  s_waitcnt lgkmcnt(0)
  s_waitcnt vmcnt(16)
  s_barrier
  v_mfma_f32_16x16x32_bf16 v[172:175], v[164:167], v[40:43], v[172:175]
  ds_read_b64_tr_b16 v[156:157], v10 offset:16384
  ds_read_b64_tr_b16 v[158:159], v10 offset:16896
  v_mfma_f32_16x16x32_bf16 v[176:179], v[164:167], v[72:75], v[176:179]
  ds_read_b64_tr_b16 v[160:161], v11 offset:16384
  ds_read_b64_tr_b16 v[162:163], v11 offset:16896
  v_mfma_f32_16x16x32_bf16 v[180:183], v[164:167], v[104:107], v[180:183]
  s_add_u32 m0, s48, 12288
  s_add_u32 s40, s45, 147456
  v_mfma_f32_16x16x32_bf16 v[184:187], v[164:167], v[136:139], v[184:187]
  buffer_load_dwordx4 v8, s[24:27], s40 offen offset:0  lds
  s_add_u32 s40, s45, 158720
  v_mfma_f32_16x16x32_bf16 v[188:191], v[168:171], v[40:43], v[188:191]
  buffer_load_dwordx4 v9, s[24:27], s40 offen offset:1024  lds
  v_mfma_f32_16x16x32_bf16 v[192:195], v[168:171], v[72:75], v[192:195]
  v_mfma_f32_16x16x32_bf16 v[196:199], v[168:171], v[104:107], v[196:199]
  v_mfma_f32_16x16x32_bf16 v[200:203], v[168:171], v[136:139], v[200:203]
  s_waitcnt lgkmcnt(0)
  s_waitcnt vmcnt(16)
  s_barrier
  v_mfma_f32_16x16x32_bf16 v[172:175], v[156:159], v[44:47], v[172:175]
  ds_read_b64_tr_b16 v[164:165], v10 offset:20480
  ds_read_b64_tr_b16 v[166:167], v10 offset:20992
  v_mfma_f32_16x16x32_bf16 v[176:179], v[156:159], v[76:79], v[176:179]
  ds_read_b64_tr_b16 v[168:169], v11 offset:20480
  ds_read_b64_tr_b16 v[170:171], v11 offset:20992
  v_mfma_f32_16x16x32_bf16 v[180:183], v[156:159], v[108:111], v[180:183]
  s_add_u32 m0, s48, 16384
  s_add_u32 s40, s45, 196608
  v_mfma_f32_16x16x32_bf16 v[184:187], v[156:159], v[140:143], v[184:187]
  buffer_load_dwordx4 v8, s[24:27], s40 offen offset:0  lds
  s_add_u32 s40, s45, 207872
  v_mfma_f32_16x16x32_bf16 v[188:191], v[160:163], v[44:47], v[188:191]
  buffer_load_dwordx4 v9, s[24:27], s40 offen offset:1024  lds
  v_mfma_f32_16x16x32_bf16 v[192:195], v[160:163], v[76:79], v[192:195]
  v_mfma_f32_16x16x32_bf16 v[196:199], v[160:163], v[108:111], v[196:199]
  v_mfma_f32_16x16x32_bf16 v[200:203], v[160:163], v[140:143], v[200:203]
  s_waitcnt lgkmcnt(0)
  s_waitcnt vmcnt(16)
  s_barrier
  v_mfma_f32_16x16x32_bf16 v[172:175], v[164:167], v[48:51], v[172:175]
  ds_read_b64_tr_b16 v[156:157], v10 offset:24576
  ds_read_b64_tr_b16 v[158:159], v10 offset:25088
  v_mfma_f32_16x16x32_bf16 v[176:179], v[164:167], v[80:83], v[176:179]
  ds_read_b64_tr_b16 v[160:161], v11 offset:24576
  ds_read_b64_tr_b16 v[162:163], v11 offset:25088
  v_mfma_f32_16x16x32_bf16 v[180:183], v[164:167], v[112:115], v[180:183]
  s_add_u32 m0, s48, 20480
  s_add_u32 s40, s45, 245760
  v_mfma_f32_16x16x32_bf16 v[184:187], v[164:167], v[144:147], v[184:187]
  buffer_load_dwordx4 v8, s[24:27], s40 offen offset:0  lds
  s_add_u32 s40, s45, 257024
  v_mfma_f32_16x16x32_bf16 v[188:191], v[168:171], v[48:51], v[188:191]
  buffer_load_dwordx4 v9, s[24:27], s40 offen offset:1024  lds
  v_mfma_f32_16x16x32_bf16 v[192:195], v[168:171], v[80:83], v[192:195]
  v_mfma_f32_16x16x32_bf16 v[196:199], v[168:171], v[112:115], v[196:199]
  v_mfma_f32_16x16x32_bf16 v[200:203], v[168:171], v[144:147], v[200:203]
  s_waitcnt lgkmcnt(0)
  s_waitcnt vmcnt(16)
  s_barrier
  v_mfma_f32_16x16x32_bf16 v[172:175], v[156:159], v[52:55], v[172:175]
  ds_read_b64_tr_b16 v[164:165], v10 offset:28672
  ds_read_b64_tr_b16 v[166:167], v10 offset:29184
  v_mfma_f32_16x16x32_bf16 v[176:179], v[156:159], v[84:87], v[176:179]
  ds_read_b64_tr_b16 v[168:169], v11 offset:28672
  ds_read_b64_tr_b16 v[170:171], v11 offset:29184
  v_mfma_f32_16x16x32_bf16 v[180:183], v[156:159], v[116:119], v[180:183]
  s_add_u32 m0, s48, 24576
  s_add_u32 s40, s45, 294912
  v_mfma_f32_16x16x32_bf16 v[184:187], v[156:159], v[148:151], v[184:187]
  buffer_load_dwordx4 v8, s[24:27], s40 offen offset:0  lds
  s_add_u32 s40, s45, 306176
  v_mfma_f32_16x16x32_bf16 v[188:191], v[160:163], v[52:55], v[188:191]
  buffer_load_dwordx4 v9, s[24:27], s40 offen offset:1024  lds
  v_mfma_f32_16x16x32_bf16 v[192:195], v[160:163], v[84:87], v[192:195]
  v_mfma_f32_16x16x32_bf16 v[196:199], v[160:163], v[116:119], v[196:199]
  v_mfma_f32_16x16x32_bf16 v[200:203], v[160:163], v[148:151], v[200:203]
  s_waitcnt lgkmcnt(0)
  s_waitcnt vmcnt(12)
  s_barrier
  v_mfma_f32_16x16x32_bf16 v[172:175], v[164:167], v[56:59], v[172:175]
  ds_read_b64_tr_b16 v[156:157], v10 offset:0
  ds_read_b64_tr_b16 v[158:159], v10 offset:512
  v_mfma_f32_16x16x32_bf16 v[176:179], v[164:167], v[88:91], v[176:179]
  ds_read_b64_tr_b16 v[160:161], v11 offset:0
  ds_read_b64_tr_b16 v[162:163], v11 offset:512
  v_mfma_f32_16x16x32_bf16 v[180:183], v[164:167], v[120:123], v[180:183]
  s_add_u32 m0, s48, 28672
  s_add_u32 s40, s45, 344064
  v_mfma_f32_16x16x32_bf16 v[184:187], v[164:167], v[152:155], v[184:187]
  buffer_load_dwordx4 v8, s[24:27], s40 offen offset:0  lds
  s_add_u32 s40, s45, 355328
  v_mfma_f32_16x16x32_bf16 v[188:191], v[168:171], v[56:59], v[188:191]
  buffer_load_dwordx4 v9, s[24:27], s40 offen offset:1024  lds
  v_mfma_f32_16x16x32_bf16 v[192:195], v[168:171], v[88:91], v[192:195]
  v_mfma_f32_16x16x32_bf16 v[196:199], v[168:171], v[120:123], v[196:199]
  v_mfma_f32_16x16x32_bf16 v[200:203], v[168:171], v[152:155], v[200:203]
  s_waitcnt lgkmcnt(0)
  s_mov_b32 s46, 512
  v_cvt_pk_bf16_f32 v172, v172, v173
  v_cvt_pk_bf16_f32 v173, v174, v175
  ds_write_b64 v17, v[172:173] offset:0
  v_cvt_pk_bf16_f32 v176, v176, v177
  v_cvt_pk_bf16_f32 v177, v178, v179
  ds_write_b64 v17, v[176:177] offset:2048
  v_cvt_pk_bf16_f32 v180, v180, v181
  v_cvt_pk_bf16_f32 v181, v182, v183
  ds_write_b64 v17, v[180:181] offset:4096
  v_cvt_pk_bf16_f32 v184, v184, v185
  v_cvt_pk_bf16_f32 v185, v186, v187
  ds_write_b64 v17, v[184:185] offset:6144
  v_cvt_pk_bf16_f32 v188, v188, v189
  v_cvt_pk_bf16_f32 v189, v190, v191
  ds_write_b64 v18, v[188:189] offset:0
  v_cvt_pk_bf16_f32 v192, v192, v193
  v_cvt_pk_bf16_f32 v193, v194, v195
  ds_write_b64 v18, v[192:193] offset:2048
  v_cvt_pk_bf16_f32 v196, v196, v197
  v_cvt_pk_bf16_f32 v197, v198, v199
  ds_write_b64 v18, v[196:197] offset:4096
  v_cvt_pk_bf16_f32 v200, v200, v201
  v_cvt_pk_bf16_f32 v201, v202, v203
  ds_write_b64 v18, v[200:201] offset:6144
  s_waitcnt lgkmcnt(0)
  s_barrier
  ds_read_b128 v[204:207], v19 offset:0
  ds_read_b128 v[208:211], v19 offset:1024
  ds_read_b128 v[212:215], v19 offset:2048
  ds_read_b128 v[216:219], v19 offset:3072
  s_waitcnt lgkmcnt(3)
  s_add_u32 s40, s46, 0
  buffer_store_dwordx4 v[204:207], v23, s[28:31], s40 offen sc0 sc1
  s_waitcnt lgkmcnt(2)
  s_add_u32 s40, s46, 12288
  buffer_store_dwordx4 v[208:211], v23, s[28:31], s40 offen sc0 sc1
  s_waitcnt lgkmcnt(1)
  s_add_u32 s40, s46, 24576
  buffer_store_dwordx4 v[212:215], v23, s[28:31], s40 offen sc0 sc1
  s_waitcnt lgkmcnt(0)
  s_add_u32 s40, s46, 36864
  buffer_store_dwordx4 v[216:219], v23, s[28:31], s40 offen sc0 sc1
  s_mov_b32 s45, 1536
  s_waitcnt vmcnt(16)
  s_barrier
  v_mfma_f32_16x16x32_bf16 v[172:175], v[156:159], v[28:31], 0
  ds_read_b64_tr_b16 v[164:165], v10 offset:4096
  ds_read_b64_tr_b16 v[166:167], v10 offset:4608
  v_mfma_f32_16x16x32_bf16 v[176:179], v[156:159], v[60:63], 0
  ds_read_b64_tr_b16 v[168:169], v11 offset:4096
  ds_read_b64_tr_b16 v[170:171], v11 offset:4608
  v_mfma_f32_16x16x32_bf16 v[180:183], v[156:159], v[92:95], 0
  v_mfma_f32_16x16x32_bf16 v[184:187], v[156:159], v[124:127], 0
  v_mfma_f32_16x16x32_bf16 v[188:191], v[160:163], v[28:31], 0
  v_mfma_f32_16x16x32_bf16 v[192:195], v[160:163], v[60:63], 0
  v_mfma_f32_16x16x32_bf16 v[196:199], v[160:163], v[92:95], 0
  v_mfma_f32_16x16x32_bf16 v[200:203], v[160:163], v[124:127], 0
  s_waitcnt lgkmcnt(0)
  s_waitcnt vmcnt(14)
  s_barrier
  v_mfma_f32_16x16x32_bf16 v[172:175], v[164:167], v[32:35], v[172:175]
  ds_read_b64_tr_b16 v[156:157], v10 offset:8192
  ds_read_b64_tr_b16 v[158:159], v10 offset:8704
  v_mfma_f32_16x16x32_bf16 v[176:179], v[164:167], v[64:67], v[176:179]
  ds_read_b64_tr_b16 v[160:161], v11 offset:8192
  ds_read_b64_tr_b16 v[162:163], v11 offset:8704
  v_mfma_f32_16x16x32_bf16 v[180:183], v[164:167], v[96:99], v[180:183]
  v_mfma_f32_16x16x32_bf16 v[184:187], v[164:167], v[128:131], v[184:187]
  v_mfma_f32_16x16x32_bf16 v[188:191], v[168:171], v[32:35], v[188:191]
  v_mfma_f32_16x16x32_bf16 v[192:195], v[168:171], v[64:67], v[192:195]
  v_mfma_f32_16x16x32_bf16 v[196:199], v[168:171], v[96:99], v[196:199]
  v_mfma_f32_16x16x32_bf16 v[200:203], v[168:171], v[128:131], v[200:203]
  s_waitcnt lgkmcnt(0)
  s_waitcnt vmcnt(12)
  s_barrier
  v_mfma_f32_16x16x32_bf16 v[172:175], v[156:159], v[36:39], v[172:175]
  ds_read_b64_tr_b16 v[164:165], v10 offset:12288
  ds_read_b64_tr_b16 v[166:167], v10 offset:12800
  v_mfma_f32_16x16x32_bf16 v[176:179], v[156:159], v[68:71], v[176:179]
  ds_read_b64_tr_b16 v[168:169], v11 offset:12288
  ds_read_b64_tr_b16 v[170:171], v11 offset:12800
  v_mfma_f32_16x16x32_bf16 v[180:183], v[156:159], v[100:103], v[180:183]
  v_mfma_f32_16x16x32_bf16 v[184:187], v[156:159], v[132:135], v[184:187]
  v_mfma_f32_16x16x32_bf16 v[188:191], v[160:163], v[36:39], v[188:191]
  v_mfma_f32_16x16x32_bf16 v[192:195], v[160:163], v[68:71], v[192:195]
  v_mfma_f32_16x16x32_bf16 v[196:199], v[160:163], v[100:103], v[196:199]
  v_mfma_f32_16x16x32_bf16 v[200:203], v[160:163], v[132:135], v[200:203]
  s_waitcnt lgkmcnt(0)
  s_waitcnt vmcnt(10)
  s_barrier
  v_mfma_f32_16x16x32_bf16 v[172:175], v[164:167], v[40:43], v[172:175]
  ds_read_b64_tr_b16 v[156:157], v10 offset:16384
  ds_read_b64_tr_b16 v[158:159], v10 offset:16896
  v_mfma_f32_16x16x32_bf16 v[176:179], v[164:167], v[72:75], v[176:179]
  ds_read_b64_tr_b16 v[160:161], v11 offset:16384
  ds_read_b64_tr_b16 v[162:163], v11 offset:16896
  v_mfma_f32_16x16x32_bf16 v[180:183], v[164:167], v[104:107], v[180:183]
  v_mfma_f32_16x16x32_bf16 v[184:187], v[164:167], v[136:139], v[184:187]
  v_mfma_f32_16x16x32_bf16 v[188:191], v[168:171], v[40:43], v[188:191]
  v_mfma_f32_16x16x32_bf16 v[192:195], v[168:171], v[72:75], v[192:195]
  v_mfma_f32_16x16x32_bf16 v[196:199], v[168:171], v[104:107], v[196:199]
  v_mfma_f32_16x16x32_bf16 v[200:203], v[168:171], v[136:139], v[200:203]
  s_waitcnt lgkmcnt(0)
  s_waitcnt vmcnt(8)
  s_barrier
  v_mfma_f32_16x16x32_bf16 v[172:175], v[156:159], v[44:47], v[172:175]
  ds_read_b64_tr_b16 v[164:165], v10 offset:20480
  ds_read_b64_tr_b16 v[166:167], v10 offset:20992
  v_mfma_f32_16x16x32_bf16 v[176:179], v[156:159], v[76:79], v[176:179]
  ds_read_b64_tr_b16 v[168:169], v11 offset:20480
  ds_read_b64_tr_b16 v[170:171], v11 offset:20992
  v_mfma_f32_16x16x32_bf16 v[180:183], v[156:159], v[108:111], v[180:183]
  v_mfma_f32_16x16x32_bf16 v[184:187], v[156:159], v[140:143], v[184:187]
  v_mfma_f32_16x16x32_bf16 v[188:191], v[160:163], v[44:47], v[188:191]
  v_mfma_f32_16x16x32_bf16 v[192:195], v[160:163], v[76:79], v[192:195]
  v_mfma_f32_16x16x32_bf16 v[196:199], v[160:163], v[108:111], v[196:199]
  v_mfma_f32_16x16x32_bf16 v[200:203], v[160:163], v[140:143], v[200:203]
  s_waitcnt lgkmcnt(0)
  s_waitcnt vmcnt(6)
  s_barrier
  v_mfma_f32_16x16x32_bf16 v[172:175], v[164:167], v[48:51], v[172:175]
  ds_read_b64_tr_b16 v[156:157], v10 offset:24576
  ds_read_b64_tr_b16 v[158:159], v10 offset:25088
  v_mfma_f32_16x16x32_bf16 v[176:179], v[164:167], v[80:83], v[176:179]
  ds_read_b64_tr_b16 v[160:161], v11 offset:24576
  ds_read_b64_tr_b16 v[162:163], v11 offset:25088
  v_mfma_f32_16x16x32_bf16 v[180:183], v[164:167], v[112:115], v[180:183]
  v_mfma_f32_16x16x32_bf16 v[184:187], v[164:167], v[144:147], v[184:187]
  v_mfma_f32_16x16x32_bf16 v[188:191], v[168:171], v[48:51], v[188:191]
  v_mfma_f32_16x16x32_bf16 v[192:195], v[168:171], v[80:83], v[192:195]
  v_mfma_f32_16x16x32_bf16 v[196:199], v[168:171], v[112:115], v[196:199]
  v_mfma_f32_16x16x32_bf16 v[200:203], v[168:171], v[144:147], v[200:203]
  s_waitcnt lgkmcnt(0)
  s_waitcnt vmcnt(4)
  s_barrier
  v_mfma_f32_16x16x32_bf16 v[172:175], v[156:159], v[52:55], v[172:175]
  ds_read_b64_tr_b16 v[164:165], v10 offset:28672
  ds_read_b64_tr_b16 v[166:167], v10 offset:29184
  v_mfma_f32_16x16x32_bf16 v[176:179], v[156:159], v[84:87], v[176:179]
  ds_read_b64_tr_b16 v[168:169], v11 offset:28672
  ds_read_b64_tr_b16 v[170:171], v11 offset:29184
  v_mfma_f32_16x16x32_bf16 v[180:183], v[156:159], v[116:119], v[180:183]
  v_mfma_f32_16x16x32_bf16 v[184:187], v[156:159], v[148:151], v[184:187]
  v_mfma_f32_16x16x32_bf16 v[188:191], v[160:163], v[52:55], v[188:191]
  v_mfma_f32_16x16x32_bf16 v[192:195], v[160:163], v[84:87], v[192:195]
  v_mfma_f32_16x16x32_bf16 v[196:199], v[160:163], v[116:119], v[196:199]
  v_mfma_f32_16x16x32_bf16 v[200:203], v[160:163], v[148:151], v[200:203]
  s_waitcnt lgkmcnt(0)
  v_mfma_f32_16x16x32_bf16 v[172:175], v[164:167], v[56:59], v[172:175]
  v_mfma_f32_16x16x32_bf16 v[176:179], v[164:167], v[88:91], v[176:179]
  v_mfma_f32_16x16x32_bf16 v[180:183], v[164:167], v[120:123], v[180:183]
  v_mfma_f32_16x16x32_bf16 v[184:187], v[164:167], v[152:155], v[184:187]
  v_mfma_f32_16x16x32_bf16 v[188:191], v[168:171], v[56:59], v[188:191]
  v_mfma_f32_16x16x32_bf16 v[192:195], v[168:171], v[88:91], v[192:195]
  v_mfma_f32_16x16x32_bf16 v[196:199], v[168:171], v[120:123], v[196:199]
  v_mfma_f32_16x16x32_bf16 v[200:203], v[168:171], v[152:155], v[200:203]
  s_mov_b32 s46, 1024
  v_cvt_pk_bf16_f32 v172, v172, v173
  v_cvt_pk_bf16_f32 v173, v174, v175
  ds_write_b64 v17, v[172:173] offset:0
  v_cvt_pk_bf16_f32 v176, v176, v177
  v_cvt_pk_bf16_f32 v177, v178, v179
  ds_write_b64 v17, v[176:177] offset:2048
  v_cvt_pk_bf16_f32 v180, v180, v181
  v_cvt_pk_bf16_f32 v181, v182, v183
  ds_write_b64 v17, v[180:181] offset:4096
  v_cvt_pk_bf16_f32 v184, v184, v185
  v_cvt_pk_bf16_f32 v185, v186, v187
  ds_write_b64 v17, v[184:185] offset:6144
  v_cvt_pk_bf16_f32 v188, v188, v189
  v_cvt_pk_bf16_f32 v189, v190, v191
  ds_write_b64 v18, v[188:189] offset:0
  v_cvt_pk_bf16_f32 v192, v192, v193
  v_cvt_pk_bf16_f32 v193, v194, v195
  ds_write_b64 v18, v[192:193] offset:2048
  v_cvt_pk_bf16_f32 v196, v196, v197
  v_cvt_pk_bf16_f32 v197, v198, v199
  ds_write_b64 v18, v[196:197] offset:4096
  v_cvt_pk_bf16_f32 v200, v200, v201
  v_cvt_pk_bf16_f32 v201, v202, v203
  ds_write_b64 v18, v[200:201] offset:6144
  s_waitcnt lgkmcnt(0)
  s_barrier
  ds_read_b128 v[204:207], v19 offset:0
  ds_read_b128 v[208:211], v19 offset:1024
  ds_read_b128 v[212:215], v19 offset:2048
  ds_read_b128 v[216:219], v19 offset:3072
  s_waitcnt lgkmcnt(3)
  s_add_u32 s40, s46, 0
  buffer_store_dwordx4 v[204:207], v23, s[28:31], s40 offen sc0 sc1
  s_waitcnt lgkmcnt(2)
  s_add_u32 s40, s46, 12288
  buffer_store_dwordx4 v[208:211], v23, s[28:31], s40 offen sc0 sc1
  s_waitcnt lgkmcnt(1)
  s_add_u32 s40, s46, 24576
  buffer_store_dwordx4 v[212:215], v23, s[28:31], s40 offen sc0 sc1
  s_waitcnt lgkmcnt(0)
  s_add_u32 s40, s46, 36864
  buffer_store_dwordx4 v[216:219], v23, s[28:31], s40 offen sc0 sc1
  s_endpgm
L_k1_exit:
  s_endpgm
.globl k2_kernel
.p2align 8
.type k2_kernel,@function
k2_kernel:
  s_cmp_ge_u32 s2, 1000
  s_cbranch_scc1 L_k2_exit
  s_load_dwordx2 s[4:5], s[0:1], 0
  s_load_dwordx4 s[8:11], s[0:1], 56
  s_load_dwordx2 s[6:7], s[0:1], 80
  v_and_b32 v1, 63, v0
  v_lshrrev_b32 v2, 6, v0
  s_nop 0
  v_readfirstlane_b32 s3, v2
  s_and_b32 s12, s2, 7
  s_lshr_b32 s13, s2, 3
  s_lshr_b32 s14, s12, 1
  s_and_b32 s15, s12, 1
  s_mul_i32 s40, s13, 80
  s_lshl_b32 s41, s14, 7
  v_and_b32 v9, 7, v1
  v_lshlrev_b32 v9, 4, v9
  v_add_u32 v8, s41, v9
  v_lshrrev_b32 v4, 3, v1
  v_add_u32 v5, s40, v4
  v_lshl_add_u32 v5, v5, 7, v9
  s_lshl_b32 s44, s3, 10
  v_add_u32 v5, s44, v5
  v_add_u32 v10, s40, v0
  v_lshlrev_b32 v10, 2, v10
  v_and_b32 v6, 3, v4
  v_mul_u32_u24 v6, 1536, v6
  v_lshrrev_b32 v7, 2, v4
  v_lshl_add_u32 v6, v7, 9, v6
  v_add_u32 v6, v6, v8
  v_add_u32 v7, 1024, v6
  v_cmp_lt_u32 vcc, 3, v4
  v_mov_b32 v12, 0x10000
  s_nop 0
  v_cndmask_b32 v7, v7, v12, vcc
  s_waitcnt lgkmcnt(0)
  s_mov_b32 s20, s8
  s_mov_b32 s21, s9
  s_mov_b32 s22, 6144
  s_mov_b32 s23, 0x20000
  s_mov_b32 m0, 26752
  s_nop 0
  buffer_load_dwordx4 v6, s[20:23], 0 offen lds
  s_mov_b32 m0, 27776
  s_add_u32 s32, s6, 0x1000000
  s_addc_u32 s33, s7, 0
  s_mov_b32 s34, 40004
  s_mov_b32 s35, 0x20000
  buffer_load_dwordx4 v7, s[20:23], 0 offen lds
  buffer_load_dword v10, v10, s[32:35], 0 offen
  s_load_dword s56, s[32:33], 40000
  s_add_u32 s36, s6, 0x1100000
  s_addc_u32 s37, s7, 0
  s_mov_b32 s38, 1280000
  s_mov_b32 s39, 0x20000
  s_add_u32 m0, s44, 0
  s_nop 0
  buffer_load_dwordx4 v5, s[36:39], 0 offen  lds
  v_add_u32 v5, 4096, v5
  s_add_u32 m0, s44, 4096
  s_nop 0
  buffer_load_dwordx4 v5, s[36:39], 0 offen  lds
  v_add_u32 v5, 4096, v5
  s_cmp_ge_u32 s3, 2
  s_cbranch_scc1 L_k2_lines_done
  s_add_u32 m0, s44, 8192
  s_nop 0
  buffer_load_dwordx4 v5, s[36:39], 0 offen  lds
  v_add_u32 v5, 4096, v5
L_k2_lines_done:
  s_mov_b32 s16, s4
  s_mov_b32 s17, s5
  s_mov_b32 s18, 20480000
  s_mov_b32 s19, 0x20000
  s_mov_b32 s24, s10
  s_mov_b32 s25, s11
  s_mov_b32 s26, 20480000
  s_mov_b32 s27, 0x20000
  s_mov_b32 s28, s6
  s_mov_b32 s29, s7
  s_mov_b32 s30, 15360000
  s_mov_b32 s31, 0x20000
  s_cmp_lt_u32 s40, 8800
  s_cbranch_scc1 L_k2_pfv_skip
  s_mul_i32 s52, s3, 20
  s_add_u32 s52, s52, s40
  v_lshrrev_b32 v13, 1, v1
  v_add_u32 v13, s52, v13
  v_lshlrev_b32 v13, 11, v13
  v_and_b32 v12, 1, v1
  v_lshl_add_u32 v13, v12, 9, v13
  s_lshl_b32 s53, s15, 10
  s_add_u32 s53, s53, s41
  v_add_u32 v13, s53, v13
  v_cmp_gt_u32 vcc, 40, v1
  s_nop 0
  s_and_saveexec_b64 s[46:47], vcc
  buffer_load_dword v65, v13, s[16:19], 0 offen
  s_mov_b64 exec, s[46:47]
L_k2_pfv_skip:
  v_lshlrev_b32 v3, 2, v1
  v_mov_b32 v12, 0
  v_mov_b32 v13, 0
  v_mov_b32 v14, 0
  v_mov_b32 v15, 0xffff0000
  s_cmp_lg_u32 s3, 0
  s_cbranch_scc1 L_k2_i1
  ds_write_b32 v3, v12 offset:29312
  ds_write_b32 v12, v12 offset:29984
L_k2_i1:
  s_cmp_lg_u32 s3, 1
  s_cbranch_scc1 L_k2_i2
  v_cmp_gt_u32 vcc, 8, v1
  s_nop 0
  s_and_saveexec_b64 s[46:47], vcc
  v_lshlrev_b32 v3, 4, v1
  ds_write_b128 v3, v[12:15] offset:10240
  s_mov_b64 exec, s[46:47]
L_k2_i2:
  s_waitcnt vmcnt(3)
  v_and_b32 v18, 7, v1
  v_lshrrev_b32 v19, 4, v1
  v_lshl_add_u32 v18, v18, 3, v19
  v_lshlrev_b32 v18, 1, v18
  v_and_b32 v19, 8, v1
  v_cmp_eq_u32 s[48:49], 0, v19
  ds_read_u16 v26, v18 offset:26752
  ds_read_u16_d16_hi v50, v18 offset:26880
  ds_read_u16 v27, v18 offset:27008
  ds_read_u16_d16_hi v51, v18 offset:27136
  ds_read_u16 v30, v18 offset:26760
  ds_read_u16_d16_hi v52, v18 offset:26888
  ds_read_u16 v31, v18 offset:27016
  ds_read_u16_d16_hi v53, v18 offset:27144
  ds_read_u16 v34, v18 offset:27264
  ds_read_u16_d16_hi v54, v18 offset:27392
  ds_read_u16 v35, v18 offset:27520
  ds_read_u16_d16_hi v55, v18 offset:27648
  ds_read_u16 v38, v18 offset:27272
  ds_read_u16_d16_hi v56, v18 offset:27400
  ds_read_u16 v39, v18 offset:27528
  ds_read_u16_d16_hi v57, v18 offset:27656
  ds_read_u16 v42, v18 offset:27776
  ds_read_u16_d16_hi v58, v18 offset:27904
  ds_read_u16 v43, v18 offset:28032
  ds_read_u16_d16_hi v59, v18 offset:28160
  ds_read_u16 v46, v18 offset:27784
  ds_read_u16_d16_hi v60, v18 offset:27912
  ds_read_u16 v47, v18 offset:28040
  ds_read_u16_d16_hi v61, v18 offset:28168
  s_waitcnt lgkmcnt(0)
  v_and_b32 v50, 0xffff0000, v50
  v_or_b32 v26, v26, v50
  v_and_b32 v51, 0xffff0000, v51
  v_or_b32 v27, v27, v51
  v_cndmask_b32 v28, v26, v12, s[48:49]
  v_cndmask_b32 v29, v27, v12, s[48:49]
  v_cndmask_b32 v26, v12, v26, s[48:49]
  v_cndmask_b32 v27, v12, v27, s[48:49]
  v_and_b32 v52, 0xffff0000, v52
  v_or_b32 v30, v30, v52
  v_and_b32 v53, 0xffff0000, v53
  v_or_b32 v31, v31, v53
  v_cndmask_b32 v32, v30, v12, s[48:49]
  v_cndmask_b32 v33, v31, v12, s[48:49]
  v_cndmask_b32 v30, v12, v30, s[48:49]
  v_cndmask_b32 v31, v12, v31, s[48:49]
  v_and_b32 v54, 0xffff0000, v54
  v_or_b32 v34, v34, v54
  v_and_b32 v55, 0xffff0000, v55
  v_or_b32 v35, v35, v55
  v_cndmask_b32 v36, v34, v12, s[48:49]
  v_cndmask_b32 v37, v35, v12, s[48:49]
  v_cndmask_b32 v34, v12, v34, s[48:49]
  v_cndmask_b32 v35, v12, v35, s[48:49]
  v_and_b32 v56, 0xffff0000, v56
  v_or_b32 v38, v38, v56
  v_and_b32 v57, 0xffff0000, v57
  v_or_b32 v39, v39, v57
  v_cndmask_b32 v40, v38, v12, s[48:49]
  v_cndmask_b32 v41, v39, v12, s[48:49]
  v_cndmask_b32 v38, v12, v38, s[48:49]
  v_cndmask_b32 v39, v12, v39, s[48:49]
  v_and_b32 v58, 0xffff0000, v58
  v_or_b32 v42, v42, v58
  v_and_b32 v59, 0xffff0000, v59
  v_or_b32 v43, v43, v59
  v_cndmask_b32 v44, v42, v12, s[48:49]
  v_cndmask_b32 v45, v43, v12, s[48:49]
  v_cndmask_b32 v42, v12, v42, s[48:49]
  v_cndmask_b32 v43, v12, v43, s[48:49]
  v_and_b32 v60, 0xffff0000, v60
  v_or_b32 v46, v46, v60
  v_and_b32 v61, 0xffff0000, v61
  v_or_b32 v47, v47, v61
  v_cndmask_b32 v48, v46, v12, s[48:49]
  v_cndmask_b32 v49, v47, v12, s[48:49]
  v_cndmask_b32 v46, v12, v46, s[48:49]
  v_cndmask_b32 v47, v12, v47, s[48:49]
  v_lshrrev_b32 v66, 3, v1
  v_bfe_u32 v67, v1, 2, 2
  v_lshlrev_b32 v67, 1, v67
  v_and_b32 v68, 3, v1
  v_lshrrev_b32 v69, 4, v1
  v_cmp_eq_u32 s[48:49], v68, v69
  v_cmp_gt_u32 vcc, 80, v0
  s_nop 0
  s_mov_b64 s[46:47], vcc
  v_sub_u32 v21, 63, v1
  v_lshlrev_b32 v21, 2, v21
  s_cmp_lt_u32 s40, 8800
  s_cbranch_scc1 L_k2_pfv_w1
  s_waitcnt vmcnt(1) lgkmcnt(0)
  s_branch L_k2_pfv_w2
L_k2_pfv_w1:
  s_waitcnt vmcnt(0) lgkmcnt(0)
L_k2_pfv_w2:
  v_min_u32 v18, 33, v10
  v_lshlrev_b32 v19, 2, v0
  s_mov_b64 exec, s[46:47]
  ds_write_b32 v19, v10 offset:28800
  s_mov_b64 exec, -1
  v_lshlrev_b32 v19, 2, v18
  v_mov_b32 v20, 1
  s_waitcnt lgkmcnt(0)
  s_barrier
  s_mov_b64 exec, s[46:47]
  ds_add_rtn_u32 v17, v19, v20 offset:29312
  s_mov_b64 exec, -1
  s_add_u32 s43, s56, 7
  s_and_b32 s43, s43, 0xfffffff8
  s_add_u32 s50, s43, 32
  v_max_u32 v24, 1, v10
  v_mov_b32 v25, s50
  v_cmp_lt_u32 vcc, 32, v10
  s_nop 1
  v_cndmask_b32 v24, v24, v25, vcc
  s_waitcnt lgkmcnt(0)
  s_barrier
  ds_read_b32 v19, v21 offset:29312
  v_sub_u32 v22, 63, v18
  v_lshlrev_b32 v22, 2, v22
  s_waitcnt lgkmcnt(0)
  v_mov_b32 v20, v19
  v_mov_b32 v23, 0
  s_nop 1
  v_mov_b32_dpp v23, v20 row_shr:1 row_mask:0xf bank_mask:0xf
  v_add_u32 v20, v20, v23
  v_mov_b32 v23, 0
  s_nop 1
  v_mov_b32_dpp v23, v20 row_shr:2 row_mask:0xf bank_mask:0xf
  v_add_u32 v20, v20, v23
  v_mov_b32 v23, 0
  s_nop 1
  v_mov_b32_dpp v23, v20 row_shr:4 row_mask:0xf bank_mask:0xf
  v_add_u32 v20, v20, v23
  v_mov_b32 v23, 0
  s_nop 1
  v_mov_b32_dpp v23, v20 row_shr:8 row_mask:0xf bank_mask:0xf
  v_add_u32 v20, v20, v23
  v_mov_b32 v23, 0
  s_nop 1
  v_mov_b32_dpp v23, v20 row_bcast:15 row_mask:0xa bank_mask:0xf
  v_add_u32 v20, v20, v23
  v_mov_b32 v23, 0
  s_nop 1
  v_mov_b32_dpp v23, v20 row_bcast:31 row_mask:0xc bank_mask:0xf
  v_add_u32 v20, v20, v23
  v_sub_u32 v20, v20, v19
  ds_bpermute_b32 v22, v22, v20
  s_waitcnt lgkmcnt(0)
  v_add_u32 v22, v22, v17
  v_lshlrev_b32 v21, 2, v22
  v_and_b32 v19, 7, v22
  v_cmp_eq_u32 vcc, 0, v19
  s_nop 0
  s_and_b64 vcc, vcc, s[46:47]
  s_mov_b64 exec, s[46:47]
  ds_write_b32 v21, v0 offset:29568
  s_mov_b64 exec, vcc
  v_lshrrev_b32 v21, 1, v22
  ds_write_b32 v21, v24 offset:29888
  s_mov_b64 exec, -1
  s_sub_u32 s51, 3, s3
  s_waitcnt lgkmcnt(0)
  s_barrier
  v_lshlrev_b32 v2, 2, v66
  v_lshlrev_b32 v3, 2, v67
  s_add_u32 s44, s6, 0x1800000
  s_addc_u32 s45, s7, 0
  s_mov_b32 s46, 5120000
  s_mov_b32 s47, 0x20000
  s_add_u32 s36, s6, 0x1240000
  s_addc_u32 s37, s7, 0
  s_mov_b32 s38, 3840000
  s_mov_b32 s39, 0x20000
  s_mul_i32 s42, s3, 4096
  s_add_u32 s42, s42, 10368
  v_lshlrev_b32 v15, 4, v1
  v_add_u32 v15, s42, v15
  s_mov_b32 s57, 1536
  s_cmp_eq_u32 s15, 1
  s_cbranch_scc1 L_k2_par1
  s_mov_b32 s58, 0
  v_mov_b32 v4, 0
  v_mov_b32 v5, 1
  s_mov_b64 exec, 1
  ds_add_rtn_u32 v4, v4, v5 offset:29984
  s_mov_b64 exec, -1
  s_waitcnt lgkmcnt(0)
  v_readfirstlane_b32 s60, v4
  s_mov_b32 s59, 0
  s_cmp_ge_u32 s60, 10
  s_cbranch_scc1 L_p0_sg_fin_1
  s_lshl_b32 s61, s60, 5
  v_add_u32 v4, s61, v2
  v_add_u32 v5, s61, v3
  s_lshl_b32 s61, s60, 2
  v_mov_b32 v6, s61
  ds_read_b32 v11, v4 offset:29568
  ds_read_b32 v13, v5 offset:29568
  ds_read_b32 v14, v5 offset:29572
  ds_read_b32 v6, v6 offset:29888
  v_mov_b32 v7, 80
  s_waitcnt lgkmcnt(0)
  v_cndmask_b32 v13, v7, v13, s[48:49]
  v_cndmask_b32 v14, v7, v14, s[48:49]
  v_readfirstlane_b32 s59, v6
  v_lshlrev_b32 v12, 7, v11
  v_lshlrev_b32 v13, 7, v13
  v_lshlrev_b32 v14, 7, v14
  s_min_u32 s59, s59, s50
  s_cmp_ge_u32 s59, 8
  s_cbranch_scc0 L_p0_sg_lo_2
  s_setprio 3
  s_branch L_p0_sg_fin_1
L_p0_sg_lo_2:
  s_setprio 0
L_p0_sg_fin_1:
  s_cmp_eq_u32 s59, 0
  s_cselect_b32 s68, 0, 1
  s_cbranch_scc1 L_p0_iss_end_3
  ds_read_b64 v[16:17], v12 offset:8
  ds_read_b64 v[98:99], v13 offset:0
  ds_read_b64 v[100:101], v14 offset:0
  s_waitcnt lgkmcnt(0)
  s_cmp_eq_u32 s58, 0
  s_cselect_b32 s76, 1, 0
  s_cbranch_scc0 L_p0_nosv_4
  v_add_u32 v18, s40, v11
  v_lshl_add_u32 v18, v18, 11, v8
  s_add_u32 m0, s42, 0
  v_mov_b32 v19, v18
  buffer_load_dwordx4 v19, s[16:19], 0 offen  lds
  s_add_u32 m0, s42, 1024
  v_add_u32 v19, 512, v18
  buffer_load_dwordx4 v19, s[16:19], 0 offen  lds
L_p0_nosv_4:
  v_lshrrev_b32 v18, 16, v17
  v_mad_u32_u24 v19, v18, s57, v8
  v_lshl_add_u32 v20, v18, 11, v8
  buffer_load_dwordx4 v[82:85], v19, s[28:31], 0 offen offset:0
  buffer_load_dwordx4 v[86:89], v19, s[28:31], 0 offen offset:512
  buffer_load_dwordx4 v[90:93], v19, s[28:31], 0 offen offset:1024
  buffer_load_dwordx4 v[94:97], v20, s[16:19], 0 offen offset:512
  v_lshlrev_b32 v122, 16, v16
  v_mov_b32 v124, v11
  s_add_u32 s58, s58, 1
  s_cmp_ge_u32 s58, s59
  s_cselect_b32 s72, 1, 0
  s_cbranch_scc1 L_p0_adv_next_5
  v_add_u32 v12, 16, v12
  v_add_u32 v13, 16, v13
  v_add_u32 v14, 16, v14
  s_branch L_p0_adv_done_6
L_p0_adv_next_5:
  s_mov_b32 s58, 0
  v_mov_b32 v4, 0
  v_mov_b32 v5, 1
  s_mov_b64 exec, 1
  ds_add_rtn_u32 v4, v4, v5 offset:29984
  s_mov_b64 exec, -1
  s_waitcnt lgkmcnt(0)
  v_readfirstlane_b32 s60, v4
  s_mov_b32 s59, 0
  s_cmp_ge_u32 s60, 10
  s_cbranch_scc1 L_p0_sg_fin_7
  s_lshl_b32 s61, s60, 5
  v_add_u32 v4, s61, v2
  v_add_u32 v5, s61, v3
  s_lshl_b32 s61, s60, 2
  v_mov_b32 v6, s61
  ds_read_b32 v11, v4 offset:29568
  ds_read_b32 v13, v5 offset:29568
  ds_read_b32 v14, v5 offset:29572
  ds_read_b32 v6, v6 offset:29888
  v_mov_b32 v7, 80
  s_waitcnt lgkmcnt(0)
  v_cndmask_b32 v13, v7, v13, s[48:49]
  v_cndmask_b32 v14, v7, v14, s[48:49]
  v_readfirstlane_b32 s59, v6
  v_lshlrev_b32 v12, 7, v11
  v_lshlrev_b32 v13, 7, v13
  v_lshlrev_b32 v14, 7, v14
  s_min_u32 s59, s59, s50
  s_cmp_ge_u32 s59, 8
  s_cbranch_scc0 L_p0_sg_lo_8
  s_setprio 3
  s_branch L_p0_sg_fin_7
L_p0_sg_lo_8:
  s_setprio 0
L_p0_sg_fin_7:
L_p0_adv_done_6:
L_p0_iss_end_3:
  s_cmp_eq_u32 s59, 0
  s_cselect_b32 s69, 0, 1
  s_cbranch_scc1 L_p0_iss_end_9
  ds_read_b64 v[16:17], v12 offset:8
  ds_read_b64 v[118:119], v13 offset:0
  ds_read_b64 v[120:121], v14 offset:0
  s_waitcnt lgkmcnt(0)
  s_cmp_eq_u32 s58, 0
  s_cselect_b32 s77, 1, 0
  s_cbranch_scc0 L_p0_nosv_10
  v_add_u32 v18, s40, v11
  v_lshl_add_u32 v18, v18, 11, v8
  s_add_u32 m0, s42, 2048
  v_mov_b32 v19, v18
  buffer_load_dwordx4 v19, s[16:19], 0 offen  lds
  s_add_u32 m0, s42, 3072
  v_add_u32 v19, 512, v18
  buffer_load_dwordx4 v19, s[16:19], 0 offen  lds
L_p0_nosv_10:
  v_lshrrev_b32 v18, 16, v17
  v_mad_u32_u24 v19, v18, s57, v8
  v_lshl_add_u32 v20, v18, 11, v8
  buffer_load_dwordx4 v[102:105], v19, s[28:31], 0 offen offset:0
  buffer_load_dwordx4 v[106:109], v19, s[28:31], 0 offen offset:512
  buffer_load_dwordx4 v[110:113], v19, s[28:31], 0 offen offset:1024
  buffer_load_dwordx4 v[114:117], v20, s[16:19], 0 offen offset:512
  v_lshlrev_b32 v125, 16, v16
  v_mov_b32 v127, v11
  s_add_u32 s58, s58, 1
  s_cmp_ge_u32 s58, s59
  s_cselect_b32 s73, 1, 0
  s_cbranch_scc1 L_p0_adv_next_11
  v_add_u32 v12, 16, v12
  v_add_u32 v13, 16, v13
  v_add_u32 v14, 16, v14
  s_branch L_p0_adv_done_12
L_p0_adv_next_11:
  s_mov_b32 s58, 0
  v_mov_b32 v4, 0
  v_mov_b32 v5, 1
  s_mov_b64 exec, 1
  ds_add_rtn_u32 v4, v4, v5 offset:29984
  s_mov_b64 exec, -1
  s_waitcnt lgkmcnt(0)
  v_readfirstlane_b32 s60, v4
  s_mov_b32 s59, 0
  s_cmp_ge_u32 s60, 10
  s_cbranch_scc1 L_p0_sg_fin_13
  s_lshl_b32 s61, s60, 5
  v_add_u32 v4, s61, v2
  v_add_u32 v5, s61, v3
  s_lshl_b32 s61, s60, 2
  v_mov_b32 v6, s61
  ds_read_b32 v11, v4 offset:29568
  ds_read_b32 v13, v5 offset:29568
  ds_read_b32 v14, v5 offset:29572
  ds_read_b32 v6, v6 offset:29888
  v_mov_b32 v7, 80
  s_waitcnt lgkmcnt(0)
  v_cndmask_b32 v13, v7, v13, s[48:49]
  v_cndmask_b32 v14, v7, v14, s[48:49]
  v_readfirstlane_b32 s59, v6
  v_lshlrev_b32 v12, 7, v11
  v_lshlrev_b32 v13, 7, v13
  v_lshlrev_b32 v14, 7, v14
  s_min_u32 s59, s59, s50
  s_cmp_ge_u32 s59, 8
  s_cbranch_scc0 L_p0_sg_lo_14
  s_setprio 3
  s_branch L_p0_sg_fin_13
L_p0_sg_lo_14:
  s_setprio 0
L_p0_sg_fin_13:
L_p0_adv_done_12:
L_p0_iss_end_9:
L_p0_loop:
  s_cmp_eq_u32 s68, 0
  s_cbranch_scc1 L_p0_end
  s_cmp_eq_u32 s69, 0
  s_cbranch_scc1 L_p0_w0_15
  s_waitcnt vmcnt(4)
  s_branch L_p0_w1_16
L_p0_w0_15:
  s_waitcnt vmcnt(0)
L_p0_w1_16:
  s_cmp_eq_u32 s76, 0
  s_cbranch_scc1 L_p0_noini_17
  ds_read_b128 v[66:69], v15 offset:0
  ds_read_b128 v[70:73], v15 offset:1024
  s_waitcnt lgkmcnt(0)
  v_lshlrev_b32 v50, 16, v66
  v_and_b32 v51, 0xffff0000, v66
  v_lshlrev_b32 v52, 16, v67
  v_and_b32 v53, 0xffff0000, v67
  v_lshlrev_b32 v54, 16, v68
  v_and_b32 v55, 0xffff0000, v68
  v_lshlrev_b32 v56, 16, v69
  v_and_b32 v57, 0xffff0000, v69
  v_lshlrev_b32 v58, 16, v70
  v_and_b32 v59, 0xffff0000, v70
  v_lshlrev_b32 v60, 16, v71
  v_and_b32 v61, 0xffff0000, v71
  v_lshlrev_b32 v62, 16, v72
  v_and_b32 v63, 0xffff0000, v72
  v_lshlrev_b32 v64, 16, v73
  v_and_b32 v65, 0xffff0000, v73
L_p0_noini_17:
  v_mfma_f32_16x16x32_bf16 v[66:69], v[98:101], v[26:29], 0
  v_mfma_f32_16x16x32_bf16 v[70:73], v[98:101], v[30:33], 0
  v_mfma_f32_16x16x32_bf16 v[74:77], v[98:101], v[34:37], 0
  v_mfma_f32_16x16x32_bf16 v[78:81], v[98:101], v[38:41], 0
  s_cmp_eq_u32 s59, 0
  s_cselect_b32 s67, 0, 1
  v_lshlrev_b32 v18, 16, v86
  v_lshlrev_b32 v19, 16, v94
  v_mul_f32 v18, v18, v19
  s_nop 1
  v_fmac_f32 v58, v18, v74
  v_and_b32 v20, 0xffff0000, v86
  v_and_b32 v21, 0xffff0000, v94
  v_mul_f32 v20, v20, v21
  v_fmac_f32 v59, v20, v75
  v_lshlrev_b32 v22, 16, v87
  v_lshlrev_b32 v23, 16, v95
  v_mul_f32 v22, v22, v23
  v_fmac_f32 v60, v22, v76
  v_and_b32 v24, 0xffff0000, v87
  v_and_b32 v25, 0xffff0000, v95
  v_mul_f32 v24, v24, v25
  v_fmac_f32 v61, v24, v77
  v_lshlrev_b32 v18, 16, v88
  v_lshlrev_b32 v19, 16, v96
  v_mul_f32 v18, v18, v19
  v_fmac_f32 v62, v18, v78
  v_and_b32 v20, 0xffff0000, v88
  v_and_b32 v21, 0xffff0000, v96
  v_mul_f32 v20, v20, v21
  v_fmac_f32 v63, v20, v79
  v_lshlrev_b32 v22, 16, v89
  v_lshlrev_b32 v23, 16, v97
  v_mul_f32 v22, v22, v23
  v_fmac_f32 v64, v22, v80
  v_and_b32 v24, 0xffff0000, v89
  v_and_b32 v25, 0xffff0000, v97
  v_mul_f32 v24, v24, v25
  v_fmac_f32 v65, v24, v81
  v_lshlrev_b32 v18, 16, v82
  v_fmac_f32 v50, v18, v66
  v_and_b32 v20, 0xffff0000, v82
  v_fmac_f32 v51, v20, v67
  v_lshlrev_b32 v22, 16, v83
  v_fmac_f32 v52, v22, v68
  v_and_b32 v24, 0xffff0000, v83
  v_fmac_f32 v53, v24, v69
  v_lshlrev_b32 v18, 16, v84
  v_fmac_f32 v54, v18, v70
  v_and_b32 v20, 0xffff0000, v84
  v_fmac_f32 v55, v20, v71
  v_lshlrev_b32 v22, 16, v85
  v_fmac_f32 v56, v22, v72
  v_and_b32 v24, 0xffff0000, v85
  v_fmac_f32 v57, v24, v73
  v_mfma_f32_16x16x32_bf16 v[66:69], v[98:101], v[42:45], 0
  v_mfma_f32_16x16x32_bf16 v[70:73], v[98:101], v[46:49], 0
  s_cmp_eq_u32 s67, 0
  s_cbranch_scc1 L_p0_noiss_18
  ds_read_b64 v[16:17], v12 offset:8
  ds_read_b64 v[98:99], v13 offset:0
  ds_read_b64 v[100:101], v14 offset:0
L_p0_noiss_18:
  v_lshlrev_b32 v82, 16, v90
  v_and_b32 v83, 0xffff0000, v90
  v_lshlrev_b32 v84, 16, v91
  v_and_b32 v85, 0xffff0000, v91
  v_lshlrev_b32 v86, 16, v92
  v_and_b32 v87, 0xffff0000, v92
  v_lshlrev_b32 v88, 16, v93
  v_and_b32 v89, 0xffff0000, v93
  v_mul_f32 v82, v82, v66
  v_mul_f32 v83, v83, v67
  v_mul_f32 v84, v84, v68
  v_mul_f32 v85, v85, v69
  v_mul_f32 v86, v86, v70
  v_mul_f32 v87, v87, v71
  v_mul_f32 v88, v88, v72
  v_mul_f32 v89, v89, v73
  v_fmac_f32 v58, v82, v122
  v_fmac_f32 v59, v83, v122
  v_fmac_f32 v60, v84, v122
  v_fmac_f32 v61, v85, v122
  v_fmac_f32 v62, v86, v122
  v_fmac_f32 v63, v87, v122
  v_fmac_f32 v64, v88, v122
  v_fmac_f32 v65, v89, v122
  s_cmp_eq_u32 s72, 0
  s_cbranch_scc1 L_p0_noepi_19
  v_cvt_pk_bf16_f32 v66, v50, v51
  v_cvt_pk_bf16_f32 v67, v52, v53
  v_cvt_pk_bf16_f32 v68, v54, v55
  v_cvt_pk_bf16_f32 v69, v56, v57
  v_cvt_pk_bf16_f32 v70, v58, v59
  v_cvt_pk_bf16_f32 v71, v60, v61
  v_cvt_pk_bf16_f32 v72, v62, v63
  v_cvt_pk_bf16_f32 v73, v64, v65
  v_add_u32 v18, s40, v124
  v_lshl_add_u32 v18, v18, 11, v8
  buffer_store_dwordx4 v[66:69], v18, s[24:27], 0 offen offset:0 nt
  buffer_store_dwordx4 v[70:73], v18, s[24:27], 0 offen offset:512 nt
L_p0_noepi_19:
  s_mov_b32 s68, s67
  s_cmp_eq_u32 s67, 0
  s_cbranch_scc1 L_p0_noiss2_20
  s_waitcnt lgkmcnt(0)
  s_cmp_eq_u32 s58, 0
  s_cselect_b32 s76, 1, 0
  s_cbranch_scc0 L_p0_nosv_21
  v_add_u32 v18, s40, v11
  v_lshl_add_u32 v18, v18, 11, v8
  s_add_u32 m0, s42, 0
  v_mov_b32 v19, v18
  buffer_load_dwordx4 v19, s[16:19], 0 offen  lds
  s_add_u32 m0, s42, 1024
  v_add_u32 v19, 512, v18
  buffer_load_dwordx4 v19, s[16:19], 0 offen  lds
L_p0_nosv_21:
  v_lshrrev_b32 v18, 16, v17
  v_mad_u32_u24 v19, v18, s57, v8
  v_lshl_add_u32 v20, v18, 11, v8
  buffer_load_dwordx4 v[82:85], v19, s[28:31], 0 offen offset:0
  buffer_load_dwordx4 v[86:89], v19, s[28:31], 0 offen offset:512
  buffer_load_dwordx4 v[90:93], v19, s[28:31], 0 offen offset:1024
  buffer_load_dwordx4 v[94:97], v20, s[16:19], 0 offen offset:512
  v_lshlrev_b32 v122, 16, v16
  v_mov_b32 v124, v11
  s_add_u32 s58, s58, 1
  s_cmp_ge_u32 s58, s59
  s_cselect_b32 s72, 1, 0
  s_cbranch_scc1 L_p0_adv_next_22
  v_add_u32 v12, 16, v12
  v_add_u32 v13, 16, v13
  v_add_u32 v14, 16, v14
  s_and_b32 s54, s58, 7
  s_cmp_lg_u32 s54, 0
  s_cbranch_scc1 L_p0_adv_done_23
  s_waitcnt lgkmcnt(0)
  v_subrev_u32 v12, 128, v12
  v_subrev_u32 v13, 128, v13
  v_subrev_u32 v14, 128, v14
  v_and_b32 v66, 7, v1
  v_lshlrev_b32 v67, 2, v11
  ds_read_b32 v67, v67 offset:28800
  v_add_u32 v68, s40, v11
  v_add_u32 v69, s58, v66
  s_cmp_ge_u32 s58, 32
  s_cbranch_scc1 L_p0_rf_ovf_24
  v_mul_u32_u24 v70, 384, v68
  v_lshl_add_u32 v70, v69, 4, v70
  v_subrev_u32 v70, 128, v70
  buffer_load_dwordx4 v[74:77], v70, s[36:39], 0 offen
  s_waitcnt vmcnt(0) lgkmcnt(0)
  v_cmp_gt_u32 vcc, v67, v69
  s_nop 1
  s_branch L_p0_rf_join_25
L_p0_rf_ovf_24:
  v_subrev_u32 v69, 32, v69
  v_lshlrev_b32 v70, 5, v69
  buffer_load_dwordx4 v[74:77], v70, s[44:47], 0 offen
  buffer_load_dword v71, v70, s[44:47], 0 offen offset:16
  s_waitcnt vmcnt(0) lgkmcnt(0)
  v_cmp_eq_u32 vcc, v71, v68
  v_cmp_gt_u32 s[54:55], s56, v69
  s_nop 0
  s_and_b64 vcc, vcc, s[54:55]
  v_cmp_lt_u32 s[54:55], 32, v67
  s_nop 0
  s_and_b64 vcc, vcc, s[54:55]
L_p0_rf_join_25:
  v_cndmask_b32 v74, 0, v74, vcc
  v_cndmask_b32 v75, 0, v75, vcc
  v_cndmask_b32 v76, 0, v76, vcc
  v_mov_b32 v70, 0xffff0000
  v_cndmask_b32 v77, v70, v77, vcc
  v_lshl_add_u32 v70, v66, 4, v12
  ds_write_b128 v70, v[74:77] offset:0
  s_waitcnt lgkmcnt(0)
  s_branch L_p0_adv_done_23
L_p0_adv_next_22:
  s_mov_b32 s58, 0
  v_mov_b32 v4, 0
  v_mov_b32 v5, 1
  s_mov_b64 exec, 1
  ds_add_rtn_u32 v4, v4, v5 offset:29984
  s_mov_b64 exec, -1
  s_waitcnt lgkmcnt(0)
  v_readfirstlane_b32 s60, v4
  s_mov_b32 s59, 0
  s_cmp_ge_u32 s60, 10
  s_cbranch_scc1 L_p0_sg_fin_26
  s_lshl_b32 s61, s60, 5
  v_add_u32 v4, s61, v2
  v_add_u32 v5, s61, v3
  s_lshl_b32 s61, s60, 2
  v_mov_b32 v6, s61
  ds_read_b32 v11, v4 offset:29568
  ds_read_b32 v13, v5 offset:29568
  ds_read_b32 v14, v5 offset:29572
  ds_read_b32 v6, v6 offset:29888
  v_mov_b32 v7, 80
  s_waitcnt lgkmcnt(0)
  v_cndmask_b32 v13, v7, v13, s[48:49]
  v_cndmask_b32 v14, v7, v14, s[48:49]
  v_readfirstlane_b32 s59, v6
  v_lshlrev_b32 v12, 7, v11
  v_lshlrev_b32 v13, 7, v13
  v_lshlrev_b32 v14, 7, v14
  s_min_u32 s59, s59, s50
  s_cmp_ge_u32 s59, 8
  s_cbranch_scc0 L_p0_sg_lo_27
  s_setprio 3
  s_branch L_p0_sg_fin_26
L_p0_sg_lo_27:
  s_setprio 0
L_p0_sg_fin_26:
L_p0_adv_done_23:
L_p0_noiss2_20:
  s_cmp_eq_u32 s69, 0
  s_cbranch_scc1 L_p0_end
  s_cmp_eq_u32 s68, 0
  s_cbranch_scc1 L_p0_w0_28
  s_waitcnt vmcnt(4)
  s_branch L_p0_w1_29
L_p0_w0_28:
  s_waitcnt vmcnt(0)
L_p0_w1_29:
  s_cmp_eq_u32 s77, 0
  s_cbranch_scc1 L_p0_noini_30
  ds_read_b128 v[66:69], v15 offset:2048
  ds_read_b128 v[70:73], v15 offset:3072
  s_waitcnt lgkmcnt(0)
  v_lshlrev_b32 v50, 16, v66
  v_and_b32 v51, 0xffff0000, v66
  v_lshlrev_b32 v52, 16, v67
  v_and_b32 v53, 0xffff0000, v67
  v_lshlrev_b32 v54, 16, v68
  v_and_b32 v55, 0xffff0000, v68
  v_lshlrev_b32 v56, 16, v69
  v_and_b32 v57, 0xffff0000, v69
  v_lshlrev_b32 v58, 16, v70
  v_and_b32 v59, 0xffff0000, v70
  v_lshlrev_b32 v60, 16, v71
  v_and_b32 v61, 0xffff0000, v71
  v_lshlrev_b32 v62, 16, v72
  v_and_b32 v63, 0xffff0000, v72
  v_lshlrev_b32 v64, 16, v73
  v_and_b32 v65, 0xffff0000, v73
L_p0_noini_30:
  v_mfma_f32_16x16x32_bf16 v[66:69], v[118:121], v[26:29], 0
  v_mfma_f32_16x16x32_bf16 v[70:73], v[118:121], v[30:33], 0
  v_mfma_f32_16x16x32_bf16 v[74:77], v[118:121], v[34:37], 0
  v_mfma_f32_16x16x32_bf16 v[78:81], v[118:121], v[38:41], 0
  s_cmp_eq_u32 s59, 0
  s_cselect_b32 s67, 0, 1
  v_lshlrev_b32 v18, 16, v106
  v_lshlrev_b32 v19, 16, v114
  v_mul_f32 v18, v18, v19
  s_nop 1
  v_fmac_f32 v58, v18, v74
  v_and_b32 v20, 0xffff0000, v106
  v_and_b32 v21, 0xffff0000, v114
  v_mul_f32 v20, v20, v21
  v_fmac_f32 v59, v20, v75
  v_lshlrev_b32 v22, 16, v107
  v_lshlrev_b32 v23, 16, v115
  v_mul_f32 v22, v22, v23
  v_fmac_f32 v60, v22, v76
  v_and_b32 v24, 0xffff0000, v107
  v_and_b32 v25, 0xffff0000, v115
  v_mul_f32 v24, v24, v25
  v_fmac_f32 v61, v24, v77
  v_lshlrev_b32 v18, 16, v108
  v_lshlrev_b32 v19, 16, v116
  v_mul_f32 v18, v18, v19
  v_fmac_f32 v62, v18, v78
  v_and_b32 v20, 0xffff0000, v108
  v_and_b32 v21, 0xffff0000, v116
  v_mul_f32 v20, v20, v21
  v_fmac_f32 v63, v20, v79
  v_lshlrev_b32 v22, 16, v109
  v_lshlrev_b32 v23, 16, v117
  v_mul_f32 v22, v22, v23
  v_fmac_f32 v64, v22, v80
  v_and_b32 v24, 0xffff0000, v109
  v_and_b32 v25, 0xffff0000, v117
  v_mul_f32 v24, v24, v25
  v_fmac_f32 v65, v24, v81
  v_lshlrev_b32 v18, 16, v102
  v_fmac_f32 v50, v18, v66
  v_and_b32 v20, 0xffff0000, v102
  v_fmac_f32 v51, v20, v67
  v_lshlrev_b32 v22, 16, v103
  v_fmac_f32 v52, v22, v68
  v_and_b32 v24, 0xffff0000, v103
  v_fmac_f32 v53, v24, v69
  v_lshlrev_b32 v18, 16, v104
  v_fmac_f32 v54, v18, v70
  v_and_b32 v20, 0xffff0000, v104
  v_fmac_f32 v55, v20, v71
  v_lshlrev_b32 v22, 16, v105
  v_fmac_f32 v56, v22, v72
  v_and_b32 v24, 0xffff0000, v105
  v_fmac_f32 v57, v24, v73
  v_mfma_f32_16x16x32_bf16 v[66:69], v[118:121], v[42:45], 0
  v_mfma_f32_16x16x32_bf16 v[70:73], v[118:121], v[46:49], 0
  s_cmp_eq_u32 s67, 0
  s_cbranch_scc1 L_p0_noiss_31
  ds_read_b64 v[16:17], v12 offset:8
  ds_read_b64 v[118:119], v13 offset:0
  ds_read_b64 v[120:121], v14 offset:0
L_p0_noiss_31:
  v_lshlrev_b32 v102, 16, v110
  v_and_b32 v103, 0xffff0000, v110
  v_lshlrev_b32 v104, 16, v111
  v_and_b32 v105, 0xffff0000, v111
  v_lshlrev_b32 v106, 16, v112
  v_and_b32 v107, 0xffff0000, v112
  v_lshlrev_b32 v108, 16, v113
  v_and_b32 v109, 0xffff0000, v113
  v_mul_f32 v102, v102, v66
  v_mul_f32 v103, v103, v67
  v_mul_f32 v104, v104, v68
  v_mul_f32 v105, v105, v69
  v_mul_f32 v106, v106, v70
  v_mul_f32 v107, v107, v71
  v_mul_f32 v108, v108, v72
  v_mul_f32 v109, v109, v73
  v_fmac_f32 v58, v102, v125
  v_fmac_f32 v59, v103, v125
  v_fmac_f32 v60, v104, v125
  v_fmac_f32 v61, v105, v125
  v_fmac_f32 v62, v106, v125
  v_fmac_f32 v63, v107, v125
  v_fmac_f32 v64, v108, v125
  v_fmac_f32 v65, v109, v125
  s_cmp_eq_u32 s73, 0
  s_cbranch_scc1 L_p0_noepi_32
  v_cvt_pk_bf16_f32 v66, v50, v51
  v_cvt_pk_bf16_f32 v67, v52, v53
  v_cvt_pk_bf16_f32 v68, v54, v55
  v_cvt_pk_bf16_f32 v69, v56, v57
  v_cvt_pk_bf16_f32 v70, v58, v59
  v_cvt_pk_bf16_f32 v71, v60, v61
  v_cvt_pk_bf16_f32 v72, v62, v63
  v_cvt_pk_bf16_f32 v73, v64, v65
  v_add_u32 v18, s40, v127
  v_lshl_add_u32 v18, v18, 11, v8
  buffer_store_dwordx4 v[66:69], v18, s[24:27], 0 offen offset:0 nt
  buffer_store_dwordx4 v[70:73], v18, s[24:27], 0 offen offset:512 nt
L_p0_noepi_32:
  s_mov_b32 s69, s67
  s_cmp_eq_u32 s67, 0
  s_cbranch_scc1 L_p0_noiss2_33
  s_waitcnt lgkmcnt(0)
  s_cmp_eq_u32 s58, 0
  s_cselect_b32 s77, 1, 0
  s_cbranch_scc0 L_p0_nosv_34
  v_add_u32 v18, s40, v11
  v_lshl_add_u32 v18, v18, 11, v8
  s_add_u32 m0, s42, 2048
  v_mov_b32 v19, v18
  buffer_load_dwordx4 v19, s[16:19], 0 offen  lds
  s_add_u32 m0, s42, 3072
  v_add_u32 v19, 512, v18
  buffer_load_dwordx4 v19, s[16:19], 0 offen  lds
L_p0_nosv_34:
  v_lshrrev_b32 v18, 16, v17
  v_mad_u32_u24 v19, v18, s57, v8
  v_lshl_add_u32 v20, v18, 11, v8
  buffer_load_dwordx4 v[102:105], v19, s[28:31], 0 offen offset:0
  buffer_load_dwordx4 v[106:109], v19, s[28:31], 0 offen offset:512
  buffer_load_dwordx4 v[110:113], v19, s[28:31], 0 offen offset:1024
  buffer_load_dwordx4 v[114:117], v20, s[16:19], 0 offen offset:512
  v_lshlrev_b32 v125, 16, v16
  v_mov_b32 v127, v11
  s_add_u32 s58, s58, 1
  s_cmp_ge_u32 s58, s59
  s_cselect_b32 s73, 1, 0
  s_cbranch_scc1 L_p0_adv_next_35
  v_add_u32 v12, 16, v12
  v_add_u32 v13, 16, v13
  v_add_u32 v14, 16, v14
  s_and_b32 s54, s58, 7
  s_cmp_lg_u32 s54, 0
  s_cbranch_scc1 L_p0_adv_done_36
  s_waitcnt lgkmcnt(0)
  v_subrev_u32 v12, 128, v12
  v_subrev_u32 v13, 128, v13
  v_subrev_u32 v14, 128, v14
  v_and_b32 v66, 7, v1
  v_lshlrev_b32 v67, 2, v11
  ds_read_b32 v67, v67 offset:28800
  v_add_u32 v68, s40, v11
  v_add_u32 v69, s58, v66
  s_cmp_ge_u32 s58, 32
  s_cbranch_scc1 L_p0_rf_ovf_37
  v_mul_u32_u24 v70, 384, v68
  v_lshl_add_u32 v70, v69, 4, v70
  v_subrev_u32 v70, 128, v70
  buffer_load_dwordx4 v[74:77], v70, s[36:39], 0 offen
  s_waitcnt vmcnt(0) lgkmcnt(0)
  v_cmp_gt_u32 vcc, v67, v69
  s_nop 1
  s_branch L_p0_rf_join_38
L_p0_rf_ovf_37:
  v_subrev_u32 v69, 32, v69
  v_lshlrev_b32 v70, 5, v69
  buffer_load_dwordx4 v[74:77], v70, s[44:47], 0 offen
  buffer_load_dword v71, v70, s[44:47], 0 offen offset:16
  s_waitcnt vmcnt(0) lgkmcnt(0)
  v_cmp_eq_u32 vcc, v71, v68
  v_cmp_gt_u32 s[54:55], s56, v69
  s_nop 0
  s_and_b64 vcc, vcc, s[54:55]
  v_cmp_lt_u32 s[54:55], 32, v67
  s_nop 0
  s_and_b64 vcc, vcc, s[54:55]
L_p0_rf_join_38:
  v_cndmask_b32 v74, 0, v74, vcc
  v_cndmask_b32 v75, 0, v75, vcc
  v_cndmask_b32 v76, 0, v76, vcc
  v_mov_b32 v70, 0xffff0000
  v_cndmask_b32 v77, v70, v77, vcc
  v_lshl_add_u32 v70, v66, 4, v12
  ds_write_b128 v70, v[74:77] offset:0
  s_waitcnt lgkmcnt(0)
  s_branch L_p0_adv_done_36
L_p0_adv_next_35:
  s_mov_b32 s58, 0
  v_mov_b32 v4, 0
  v_mov_b32 v5, 1
  s_mov_b64 exec, 1
  ds_add_rtn_u32 v4, v4, v5 offset:29984
  s_mov_b64 exec, -1
  s_waitcnt lgkmcnt(0)
  v_readfirstlane_b32 s60, v4
  s_mov_b32 s59, 0
  s_cmp_ge_u32 s60, 10
  s_cbranch_scc1 L_p0_sg_fin_39
  s_lshl_b32 s61, s60, 5
  v_add_u32 v4, s61, v2
  v_add_u32 v5, s61, v3
  s_lshl_b32 s61, s60, 2
  v_mov_b32 v6, s61
  ds_read_b32 v11, v4 offset:29568
  ds_read_b32 v13, v5 offset:29568
  ds_read_b32 v14, v5 offset:29572
  ds_read_b32 v6, v6 offset:29888
  v_mov_b32 v7, 80
  s_waitcnt lgkmcnt(0)
  v_cndmask_b32 v13, v7, v13, s[48:49]
  v_cndmask_b32 v14, v7, v14, s[48:49]
  v_readfirstlane_b32 s59, v6
  v_lshlrev_b32 v12, 7, v11
  v_lshlrev_b32 v13, 7, v13
  v_lshlrev_b32 v14, 7, v14
  s_min_u32 s59, s59, s50
  s_cmp_ge_u32 s59, 8
  s_cbranch_scc0 L_p0_sg_lo_40
  s_setprio 3
  s_branch L_p0_sg_fin_39
L_p0_sg_lo_40:
  s_setprio 0
L_p0_sg_fin_39:
L_p0_adv_done_36:
L_p0_noiss2_33:
  s_branch L_p0_loop
L_p0_end:
  s_branch L_k2_fin
L_k2_par1:
  s_mov_b32 s58, 0
  v_mov_b32 v4, 0
  v_mov_b32 v5, 1
  s_mov_b64 exec, 1
  ds_add_rtn_u32 v4, v4, v5 offset:29984
  s_mov_b64 exec, -1
  s_waitcnt lgkmcnt(0)
  v_readfirstlane_b32 s60, v4
  s_mov_b32 s59, 0
  s_cmp_ge_u32 s60, 10
  s_cbranch_scc1 L_p1_sg_fin_1
  s_lshl_b32 s61, s60, 5
  v_add_u32 v4, s61, v2
  v_add_u32 v5, s61, v3
  s_lshl_b32 s61, s60, 2
  v_mov_b32 v6, s61
  ds_read_b32 v11, v4 offset:29568
  ds_read_b32 v13, v5 offset:29568
  ds_read_b32 v14, v5 offset:29572
  ds_read_b32 v6, v6 offset:29888
  v_mov_b32 v7, 80
  s_waitcnt lgkmcnt(0)
  v_cndmask_b32 v13, v7, v13, s[48:49]
  v_cndmask_b32 v14, v7, v14, s[48:49]
  v_readfirstlane_b32 s59, v6
  v_lshlrev_b32 v12, 7, v11
  v_lshlrev_b32 v13, 7, v13
  v_lshlrev_b32 v14, 7, v14
  s_min_u32 s59, s59, s50
  s_cmp_ge_u32 s59, 8
  s_cbranch_scc0 L_p1_sg_lo_2
  s_setprio 3
  s_branch L_p1_sg_fin_1
L_p1_sg_lo_2:
  s_setprio 0
L_p1_sg_fin_1:
  s_cmp_eq_u32 s59, 0
  s_cselect_b32 s68, 0, 1
  s_cbranch_scc1 L_p1_iss_end_3
  ds_read_b64 v[16:17], v12 offset:8
  ds_read_b64 v[98:99], v13 offset:0
  ds_read_b64 v[100:101], v14 offset:0
  s_waitcnt lgkmcnt(0)
  s_cmp_eq_u32 s58, 0
  s_cselect_b32 s76, 1, 0
  s_cbranch_scc0 L_p1_nosv_4
  v_add_u32 v18, s40, v11
  v_lshl_add_u32 v18, v18, 11, v8
  s_add_u32 m0, s42, 0
  v_add_u32 v19, 1024, v18
  buffer_load_dwordx4 v19, s[16:19], 0 offen  lds
  s_add_u32 m0, s42, 1024
  v_add_u32 v19, 1536, v18
  buffer_load_dwordx4 v19, s[16:19], 0 offen  lds
L_p1_nosv_4:
  v_lshrrev_b32 v18, 16, v17
  v_mad_u32_u24 v19, v18, s57, v8
  v_lshl_add_u32 v20, v18, 11, v8
  buffer_load_dwordx4 v[82:85], v19, s[28:31], 0 offen offset:512
  buffer_load_dwordx4 v[86:89], v19, s[28:31], 0 offen offset:1024
  buffer_load_dwordx4 v[90:93], v20, s[16:19], 0 offen offset:1024
  buffer_load_dwordx4 v[94:97], v20, s[16:19], 0 offen offset:1536
  v_and_b32 v122, 0xffff0000, v16
  v_lshlrev_b32 v123, 16, v17
  v_mov_b32 v124, v11
  s_add_u32 s58, s58, 1
  s_cmp_ge_u32 s58, s59
  s_cselect_b32 s72, 1, 0
  s_cbranch_scc1 L_p1_adv_next_5
  v_add_u32 v12, 16, v12
  v_add_u32 v13, 16, v13
  v_add_u32 v14, 16, v14
  s_branch L_p1_adv_done_6
L_p1_adv_next_5:
  s_mov_b32 s58, 0
  v_mov_b32 v4, 0
  v_mov_b32 v5, 1
  s_mov_b64 exec, 1
  ds_add_rtn_u32 v4, v4, v5 offset:29984
  s_mov_b64 exec, -1
  s_waitcnt lgkmcnt(0)
  v_readfirstlane_b32 s60, v4
  s_mov_b32 s59, 0
  s_cmp_ge_u32 s60, 10
  s_cbranch_scc1 L_p1_sg_fin_7
  s_lshl_b32 s61, s60, 5
  v_add_u32 v4, s61, v2
  v_add_u32 v5, s61, v3
  s_lshl_b32 s61, s60, 2
  v_mov_b32 v6, s61
  ds_read_b32 v11, v4 offset:29568
  ds_read_b32 v13, v5 offset:29568
  ds_read_b32 v14, v5 offset:29572
  ds_read_b32 v6, v6 offset:29888
  v_mov_b32 v7, 80
  s_waitcnt lgkmcnt(0)
  v_cndmask_b32 v13, v7, v13, s[48:49]
  v_cndmask_b32 v14, v7, v14, s[48:49]
  v_readfirstlane_b32 s59, v6
  v_lshlrev_b32 v12, 7, v11
  v_lshlrev_b32 v13, 7, v13
  v_lshlrev_b32 v14, 7, v14
  s_min_u32 s59, s59, s50
  s_cmp_ge_u32 s59, 8
  s_cbranch_scc0 L_p1_sg_lo_8
  s_setprio 3
  s_branch L_p1_sg_fin_7
L_p1_sg_lo_8:
  s_setprio 0
L_p1_sg_fin_7:
L_p1_adv_done_6:
L_p1_iss_end_3:
  s_cmp_eq_u32 s59, 0
  s_cselect_b32 s69, 0, 1
  s_cbranch_scc1 L_p1_iss_end_9
  ds_read_b64 v[16:17], v12 offset:8
  ds_read_b64 v[118:119], v13 offset:0
  ds_read_b64 v[120:121], v14 offset:0
  s_waitcnt lgkmcnt(0)
  s_cmp_eq_u32 s58, 0
  s_cselect_b32 s77, 1, 0
  s_cbranch_scc0 L_p1_nosv_10
  v_add_u32 v18, s40, v11
  v_lshl_add_u32 v18, v18, 11, v8
  s_add_u32 m0, s42, 2048
  v_add_u32 v19, 1024, v18
  buffer_load_dwordx4 v19, s[16:19], 0 offen  lds
  s_add_u32 m0, s42, 3072
  v_add_u32 v19, 1536, v18
  buffer_load_dwordx4 v19, s[16:19], 0 offen  lds
L_p1_nosv_10:
  v_lshrrev_b32 v18, 16, v17
  v_mad_u32_u24 v19, v18, s57, v8
  v_lshl_add_u32 v20, v18, 11, v8
  buffer_load_dwordx4 v[102:105], v19, s[28:31], 0 offen offset:512
  buffer_load_dwordx4 v[106:109], v19, s[28:31], 0 offen offset:1024
  buffer_load_dwordx4 v[110:113], v20, s[16:19], 0 offen offset:1024
  buffer_load_dwordx4 v[114:117], v20, s[16:19], 0 offen offset:1536
  v_and_b32 v125, 0xffff0000, v16
  v_lshlrev_b32 v126, 16, v17
  v_mov_b32 v127, v11
  s_add_u32 s58, s58, 1
  s_cmp_ge_u32 s58, s59
  s_cselect_b32 s73, 1, 0
  s_cbranch_scc1 L_p1_adv_next_11
  v_add_u32 v12, 16, v12
  v_add_u32 v13, 16, v13
  v_add_u32 v14, 16, v14
  s_branch L_p1_adv_done_12
L_p1_adv_next_11:
  s_mov_b32 s58, 0
  v_mov_b32 v4, 0
  v_mov_b32 v5, 1
  s_mov_b64 exec, 1
  ds_add_rtn_u32 v4, v4, v5 offset:29984
  s_mov_b64 exec, -1
  s_waitcnt lgkmcnt(0)
  v_readfirstlane_b32 s60, v4
  s_mov_b32 s59, 0
  s_cmp_ge_u32 s60, 10
  s_cbranch_scc1 L_p1_sg_fin_13
  s_lshl_b32 s61, s60, 5
  v_add_u32 v4, s61, v2
  v_add_u32 v5, s61, v3
  s_lshl_b32 s61, s60, 2
  v_mov_b32 v6, s61
  ds_read_b32 v11, v4 offset:29568
  ds_read_b32 v13, v5 offset:29568
  ds_read_b32 v14, v5 offset:29572
  ds_read_b32 v6, v6 offset:29888
  v_mov_b32 v7, 80
  s_waitcnt lgkmcnt(0)
  v_cndmask_b32 v13, v7, v13, s[48:49]
  v_cndmask_b32 v14, v7, v14, s[48:49]
  v_readfirstlane_b32 s59, v6
  v_lshlrev_b32 v12, 7, v11
  v_lshlrev_b32 v13, 7, v13
  v_lshlrev_b32 v14, 7, v14
  s_min_u32 s59, s59, s50
  s_cmp_ge_u32 s59, 8
  s_cbranch_scc0 L_p1_sg_lo_14
  s_setprio 3
  s_branch L_p1_sg_fin_13
L_p1_sg_lo_14:
  s_setprio 0
L_p1_sg_fin_13:
L_p1_adv_done_12:
L_p1_iss_end_9:
L_p1_loop:
  s_cmp_eq_u32 s68, 0
  s_cbranch_scc1 L_p1_end
  s_cmp_eq_u32 s69, 0
  s_cbranch_scc1 L_p1_w0_15
  s_waitcnt vmcnt(4)
  s_branch L_p1_w1_16
L_p1_w0_15:
  s_waitcnt vmcnt(0)
L_p1_w1_16:
  s_cmp_eq_u32 s76, 0
  s_cbranch_scc1 L_p1_noini_17
  ds_read_b128 v[66:69], v15 offset:0
  ds_read_b128 v[70:73], v15 offset:1024
  s_waitcnt lgkmcnt(0)
  v_lshlrev_b32 v50, 16, v66
  v_and_b32 v51, 0xffff0000, v66
  v_lshlrev_b32 v52, 16, v67
  v_and_b32 v53, 0xffff0000, v67
  v_lshlrev_b32 v54, 16, v68
  v_and_b32 v55, 0xffff0000, v68
  v_lshlrev_b32 v56, 16, v69
  v_and_b32 v57, 0xffff0000, v69
  v_lshlrev_b32 v58, 16, v70
  v_and_b32 v59, 0xffff0000, v70
  v_lshlrev_b32 v60, 16, v71
  v_and_b32 v61, 0xffff0000, v71
  v_lshlrev_b32 v62, 16, v72
  v_and_b32 v63, 0xffff0000, v72
  v_lshlrev_b32 v64, 16, v73
  v_and_b32 v65, 0xffff0000, v73
L_p1_noini_17:
  v_mfma_f32_16x16x32_bf16 v[66:69], v[98:101], v[34:37], 0
  v_mfma_f32_16x16x32_bf16 v[70:73], v[98:101], v[38:41], 0
  v_mfma_f32_16x16x32_bf16 v[74:77], v[98:101], v[42:45], 0
  v_mfma_f32_16x16x32_bf16 v[78:81], v[98:101], v[46:49], 0
  s_cmp_eq_u32 s59, 0
  s_cselect_b32 s67, 0, 1
  s_cmp_eq_u32 s67, 0
  s_cbranch_scc1 L_p1_noiss_18
  ds_read_b64 v[16:17], v12 offset:8
  ds_read_b64 v[98:99], v13 offset:0
  ds_read_b64 v[100:101], v14 offset:0
L_p1_noiss_18:
  v_lshlrev_b32 v18, 16, v82
  v_lshlrev_b32 v19, 16, v86
  v_lshlrev_b32 v20, 16, v90
  v_lshlrev_b32 v21, 16, v94
  v_mul_f32 v18, v18, v66
  v_mul_f32 v19, v19, v74
  v_fmac_f32 v50, v18, v20
  v_fmac_f32 v58, v18, v21
  v_fmac_f32 v50, v19, v122
  v_fmac_f32 v58, v19, v123
  v_and_b32 v22, 0xffff0000, v82
  v_and_b32 v23, 0xffff0000, v86
  v_and_b32 v24, 0xffff0000, v90
  v_and_b32 v25, 0xffff0000, v94
  v_mul_f32 v22, v22, v67
  v_mul_f32 v23, v23, v75
  v_fmac_f32 v51, v22, v24
  v_fmac_f32 v59, v22, v25
  v_fmac_f32 v51, v23, v122
  v_fmac_f32 v59, v23, v123
  v_lshlrev_b32 v18, 16, v83
  v_lshlrev_b32 v19, 16, v87
  v_lshlrev_b32 v20, 16, v91
  v_lshlrev_b32 v21, 16, v95
  v_mul_f32 v18, v18, v68
  v_mul_f32 v19, v19, v76
  v_fmac_f32 v52, v18, v20
  v_fmac_f32 v60, v18, v21
  v_fmac_f32 v52, v19, v122
  v_fmac_f32 v60, v19, v123
  v_and_b32 v22, 0xffff0000, v83
  v_and_b32 v23, 0xffff0000, v87
  v_and_b32 v24, 0xffff0000, v91
  v_and_b32 v25, 0xffff0000, v95
  v_mul_f32 v22, v22, v69
  v_mul_f32 v23, v23, v77
  v_fmac_f32 v53, v22, v24
  v_fmac_f32 v61, v22, v25
  v_fmac_f32 v53, v23, v122
  v_fmac_f32 v61, v23, v123
  v_lshlrev_b32 v18, 16, v84
  v_lshlrev_b32 v19, 16, v88
  v_lshlrev_b32 v20, 16, v92
  v_lshlrev_b32 v21, 16, v96
  v_mul_f32 v18, v18, v70
  v_mul_f32 v19, v19, v78
  v_fmac_f32 v54, v18, v20
  v_fmac_f32 v62, v18, v21
  v_fmac_f32 v54, v19, v122
  v_fmac_f32 v62, v19, v123
  v_and_b32 v22, 0xffff0000, v84
  v_and_b32 v23, 0xffff0000, v88
  v_and_b32 v24, 0xffff0000, v92
  v_and_b32 v25, 0xffff0000, v96
  v_mul_f32 v22, v22, v71
  v_mul_f32 v23, v23, v79
  v_fmac_f32 v55, v22, v24
  v_fmac_f32 v63, v22, v25
  v_fmac_f32 v55, v23, v122
  v_fmac_f32 v63, v23, v123
  v_lshlrev_b32 v18, 16, v85
  v_lshlrev_b32 v19, 16, v89
  v_lshlrev_b32 v20, 16, v93
  v_lshlrev_b32 v21, 16, v97
  v_mul_f32 v18, v18, v72
  v_mul_f32 v19, v19, v80
  v_fmac_f32 v56, v18, v20
  v_fmac_f32 v64, v18, v21
  v_fmac_f32 v56, v19, v122
  v_fmac_f32 v64, v19, v123
  v_and_b32 v22, 0xffff0000, v85
  v_and_b32 v23, 0xffff0000, v89
  v_and_b32 v24, 0xffff0000, v93
  v_and_b32 v25, 0xffff0000, v97
  v_mul_f32 v22, v22, v73
  v_mul_f32 v23, v23, v81
  v_fmac_f32 v57, v22, v24
  v_fmac_f32 v65, v22, v25
  v_fmac_f32 v57, v23, v122
  v_fmac_f32 v65, v23, v123
  s_cmp_eq_u32 s72, 0
  s_cbranch_scc1 L_p1_noepi_19
  v_cvt_pk_bf16_f32 v66, v50, v51
  v_cvt_pk_bf16_f32 v67, v52, v53
  v_cvt_pk_bf16_f32 v68, v54, v55
  v_cvt_pk_bf16_f32 v69, v56, v57
  v_cvt_pk_bf16_f32 v70, v58, v59
  v_cvt_pk_bf16_f32 v71, v60, v61
  v_cvt_pk_bf16_f32 v72, v62, v63
  v_cvt_pk_bf16_f32 v73, v64, v65
  v_add_u32 v18, s40, v124
  v_lshl_add_u32 v18, v18, 11, v8
  buffer_store_dwordx4 v[66:69], v18, s[24:27], 0 offen offset:1024 nt
  buffer_store_dwordx4 v[70:73], v18, s[24:27], 0 offen offset:1536 nt
L_p1_noepi_19:
  s_mov_b32 s68, s67
  s_cmp_eq_u32 s67, 0
  s_cbranch_scc1 L_p1_noiss2_20
  s_waitcnt lgkmcnt(0)
  s_cmp_eq_u32 s58, 0
  s_cselect_b32 s76, 1, 0
  s_cbranch_scc0 L_p1_nosv_21
  v_add_u32 v18, s40, v11
  v_lshl_add_u32 v18, v18, 11, v8
  s_add_u32 m0, s42, 0
  v_add_u32 v19, 1024, v18
  buffer_load_dwordx4 v19, s[16:19], 0 offen  lds
  s_add_u32 m0, s42, 1024
  v_add_u32 v19, 1536, v18
  buffer_load_dwordx4 v19, s[16:19], 0 offen  lds
L_p1_nosv_21:
  v_lshrrev_b32 v18, 16, v17
  v_mad_u32_u24 v19, v18, s57, v8
  v_lshl_add_u32 v20, v18, 11, v8
  buffer_load_dwordx4 v[82:85], v19, s[28:31], 0 offen offset:512
  buffer_load_dwordx4 v[86:89], v19, s[28:31], 0 offen offset:1024
  buffer_load_dwordx4 v[90:93], v20, s[16:19], 0 offen offset:1024
  buffer_load_dwordx4 v[94:97], v20, s[16:19], 0 offen offset:1536
  v_and_b32 v122, 0xffff0000, v16
  v_lshlrev_b32 v123, 16, v17
  v_mov_b32 v124, v11
  s_add_u32 s58, s58, 1
  s_cmp_ge_u32 s58, s59
  s_cselect_b32 s72, 1, 0
  s_cbranch_scc1 L_p1_adv_next_22
  v_add_u32 v12, 16, v12
  v_add_u32 v13, 16, v13
  v_add_u32 v14, 16, v14
  s_and_b32 s54, s58, 7
  s_cmp_lg_u32 s54, 0
  s_cbranch_scc1 L_p1_adv_done_23
  s_waitcnt lgkmcnt(0)
  v_subrev_u32 v12, 128, v12
  v_subrev_u32 v13, 128, v13
  v_subrev_u32 v14, 128, v14
  v_and_b32 v66, 7, v1
  v_lshlrev_b32 v67, 2, v11
  ds_read_b32 v67, v67 offset:28800
  v_add_u32 v68, s40, v11
  v_add_u32 v69, s58, v66
  s_cmp_ge_u32 s58, 32
  s_cbranch_scc1 L_p1_rf_ovf_24
  v_mul_u32_u24 v70, 384, v68
  v_lshl_add_u32 v70, v69, 4, v70
  v_subrev_u32 v70, 128, v70
  buffer_load_dwordx4 v[74:77], v70, s[36:39], 0 offen
  s_waitcnt vmcnt(0) lgkmcnt(0)
  v_cmp_gt_u32 vcc, v67, v69
  s_nop 1
  s_branch L_p1_rf_join_25
L_p1_rf_ovf_24:
  v_subrev_u32 v69, 32, v69
  v_lshlrev_b32 v70, 5, v69
  buffer_load_dwordx4 v[74:77], v70, s[44:47], 0 offen
  buffer_load_dword v71, v70, s[44:47], 0 offen offset:16
  s_waitcnt vmcnt(0) lgkmcnt(0)
  v_cmp_eq_u32 vcc, v71, v68
  v_cmp_gt_u32 s[54:55], s56, v69
  s_nop 0
  s_and_b64 vcc, vcc, s[54:55]
  v_cmp_lt_u32 s[54:55], 32, v67
  s_nop 0
  s_and_b64 vcc, vcc, s[54:55]
L_p1_rf_join_25:
  v_cndmask_b32 v74, 0, v74, vcc
  v_cndmask_b32 v75, 0, v75, vcc
  v_cndmask_b32 v76, 0, v76, vcc
  v_mov_b32 v70, 0xffff0000
  v_cndmask_b32 v77, v70, v77, vcc
  v_lshl_add_u32 v70, v66, 4, v12
  ds_write_b128 v70, v[74:77] offset:0
  s_waitcnt lgkmcnt(0)
  s_branch L_p1_adv_done_23
L_p1_adv_next_22:
  s_mov_b32 s58, 0
  v_mov_b32 v4, 0
  v_mov_b32 v5, 1
  s_mov_b64 exec, 1
  ds_add_rtn_u32 v4, v4, v5 offset:29984
  s_mov_b64 exec, -1
  s_waitcnt lgkmcnt(0)
  v_readfirstlane_b32 s60, v4
  s_mov_b32 s59, 0
  s_cmp_ge_u32 s60, 10
  s_cbranch_scc1 L_p1_sg_fin_26
  s_lshl_b32 s61, s60, 5
  v_add_u32 v4, s61, v2
  v_add_u32 v5, s61, v3
  s_lshl_b32 s61, s60, 2
  v_mov_b32 v6, s61
  ds_read_b32 v11, v4 offset:29568
  ds_read_b32 v13, v5 offset:29568
  ds_read_b32 v14, v5 offset:29572
  ds_read_b32 v6, v6 offset:29888
  v_mov_b32 v7, 80
  s_waitcnt lgkmcnt(0)
  v_cndmask_b32 v13, v7, v13, s[48:49]
  v_cndmask_b32 v14, v7, v14, s[48:49]
  v_readfirstlane_b32 s59, v6
  v_lshlrev_b32 v12, 7, v11
  v_lshlrev_b32 v13, 7, v13
  v_lshlrev_b32 v14, 7, v14
  s_min_u32 s59, s59, s50
  s_cmp_ge_u32 s59, 8
  s_cbranch_scc0 L_p1_sg_lo_27
  s_setprio 3
  s_branch L_p1_sg_fin_26
L_p1_sg_lo_27:
  s_setprio 0
L_p1_sg_fin_26:
L_p1_adv_done_23:
L_p1_noiss2_20:
  s_cmp_eq_u32 s69, 0
  s_cbranch_scc1 L_p1_end
  s_cmp_eq_u32 s68, 0
  s_cbranch_scc1 L_p1_w0_28
  s_waitcnt vmcnt(4)
  s_branch L_p1_w1_29
L_p1_w0_28:
  s_waitcnt vmcnt(0)
L_p1_w1_29:
  s_cmp_eq_u32 s77, 0
  s_cbranch_scc1 L_p1_noini_30
  ds_read_b128 v[66:69], v15 offset:2048
  ds_read_b128 v[70:73], v15 offset:3072
  s_waitcnt lgkmcnt(0)
  v_lshlrev_b32 v50, 16, v66
  v_and_b32 v51, 0xffff0000, v66
  v_lshlrev_b32 v52, 16, v67
  v_and_b32 v53, 0xffff0000, v67
  v_lshlrev_b32 v54, 16, v68
  v_and_b32 v55, 0xffff0000, v68
  v_lshlrev_b32 v56, 16, v69
  v_and_b32 v57, 0xffff0000, v69
  v_lshlrev_b32 v58, 16, v70
  v_and_b32 v59, 0xffff0000, v70
  v_lshlrev_b32 v60, 16, v71
  v_and_b32 v61, 0xffff0000, v71
  v_lshlrev_b32 v62, 16, v72
  v_and_b32 v63, 0xffff0000, v72
  v_lshlrev_b32 v64, 16, v73
  v_and_b32 v65, 0xffff0000, v73
L_p1_noini_30:
  v_mfma_f32_16x16x32_bf16 v[66:69], v[118:121], v[34:37], 0
  v_mfma_f32_16x16x32_bf16 v[70:73], v[118:121], v[38:41], 0
  v_mfma_f32_16x16x32_bf16 v[74:77], v[118:121], v[42:45], 0
  v_mfma_f32_16x16x32_bf16 v[78:81], v[118:121], v[46:49], 0
  s_cmp_eq_u32 s59, 0
  s_cselect_b32 s67, 0, 1
  s_cmp_eq_u32 s67, 0
  s_cbranch_scc1 L_p1_noiss_31
  ds_read_b64 v[16:17], v12 offset:8
  ds_read_b64 v[118:119], v13 offset:0
  ds_read_b64 v[120:121], v14 offset:0
L_p1_noiss_31:
  v_lshlrev_b32 v18, 16, v102
  v_lshlrev_b32 v19, 16, v106
  v_lshlrev_b32 v20, 16, v110
  v_lshlrev_b32 v21, 16, v114
  v_mul_f32 v18, v18, v66
  v_mul_f32 v19, v19, v74
  v_fmac_f32 v50, v18, v20
  v_fmac_f32 v58, v18, v21
  v_fmac_f32 v50, v19, v125
  v_fmac_f32 v58, v19, v126
  v_and_b32 v22, 0xffff0000, v102
  v_and_b32 v23, 0xffff0000, v106
  v_and_b32 v24, 0xffff0000, v110
  v_and_b32 v25, 0xffff0000, v114
  v_mul_f32 v22, v22, v67
  v_mul_f32 v23, v23, v75
  v_fmac_f32 v51, v22, v24
  v_fmac_f32 v59, v22, v25
  v_fmac_f32 v51, v23, v125
  v_fmac_f32 v59, v23, v126
  v_lshlrev_b32 v18, 16, v103
  v_lshlrev_b32 v19, 16, v107
  v_lshlrev_b32 v20, 16, v111
  v_lshlrev_b32 v21, 16, v115
  v_mul_f32 v18, v18, v68
  v_mul_f32 v19, v19, v76
  v_fmac_f32 v52, v18, v20
  v_fmac_f32 v60, v18, v21
  v_fmac_f32 v52, v19, v125
  v_fmac_f32 v60, v19, v126
  v_and_b32 v22, 0xffff0000, v103
  v_and_b32 v23, 0xffff0000, v107
  v_and_b32 v24, 0xffff0000, v111
  v_and_b32 v25, 0xffff0000, v115
  v_mul_f32 v22, v22, v69
  v_mul_f32 v23, v23, v77
  v_fmac_f32 v53, v22, v24
  v_fmac_f32 v61, v22, v25
  v_fmac_f32 v53, v23, v125
  v_fmac_f32 v61, v23, v126
  v_lshlrev_b32 v18, 16, v104
  v_lshlrev_b32 v19, 16, v108
  v_lshlrev_b32 v20, 16, v112
  v_lshlrev_b32 v21, 16, v116
  v_mul_f32 v18, v18, v70
  v_mul_f32 v19, v19, v78
  v_fmac_f32 v54, v18, v20
  v_fmac_f32 v62, v18, v21
  v_fmac_f32 v54, v19, v125
  v_fmac_f32 v62, v19, v126
  v_and_b32 v22, 0xffff0000, v104
  v_and_b32 v23, 0xffff0000, v108
  v_and_b32 v24, 0xffff0000, v112
  v_and_b32 v25, 0xffff0000, v116
  v_mul_f32 v22, v22, v71
  v_mul_f32 v23, v23, v79
  v_fmac_f32 v55, v22, v24
  v_fmac_f32 v63, v22, v25
  v_fmac_f32 v55, v23, v125
  v_fmac_f32 v63, v23, v126
  v_lshlrev_b32 v18, 16, v105
  v_lshlrev_b32 v19, 16, v109
  v_lshlrev_b32 v20, 16, v113
  v_lshlrev_b32 v21, 16, v117
  v_mul_f32 v18, v18, v72
  v_mul_f32 v19, v19, v80
  v_fmac_f32 v56, v18, v20
  v_fmac_f32 v64, v18, v21
  v_fmac_f32 v56, v19, v125
  v_fmac_f32 v64, v19, v126
  v_and_b32 v22, 0xffff0000, v105
  v_and_b32 v23, 0xffff0000, v109
  v_and_b32 v24, 0xffff0000, v113
  v_and_b32 v25, 0xffff0000, v117
  v_mul_f32 v22, v22, v73
  v_mul_f32 v23, v23, v81
  v_fmac_f32 v57, v22, v24
  v_fmac_f32 v65, v22, v25
  v_fmac_f32 v57, v23, v125
  v_fmac_f32 v65, v23, v126
  s_cmp_eq_u32 s73, 0
  s_cbranch_scc1 L_p1_noepi_32
  v_cvt_pk_bf16_f32 v66, v50, v51
  v_cvt_pk_bf16_f32 v67, v52, v53
  v_cvt_pk_bf16_f32 v68, v54, v55
  v_cvt_pk_bf16_f32 v69, v56, v57
  v_cvt_pk_bf16_f32 v70, v58, v59
  v_cvt_pk_bf16_f32 v71, v60, v61
  v_cvt_pk_bf16_f32 v72, v62, v63
  v_cvt_pk_bf16_f32 v73, v64, v65
  v_add_u32 v18, s40, v127
  v_lshl_add_u32 v18, v18, 11, v8
  buffer_store_dwordx4 v[66:69], v18, s[24:27], 0 offen offset:1024 nt
  buffer_store_dwordx4 v[70:73], v18, s[24:27], 0 offen offset:1536 nt
L_p1_noepi_32:
  s_mov_b32 s69, s67
  s_cmp_eq_u32 s67, 0
  s_cbranch_scc1 L_p1_noiss2_33
  s_waitcnt lgkmcnt(0)
  s_cmp_eq_u32 s58, 0
  s_cselect_b32 s77, 1, 0
  s_cbranch_scc0 L_p1_nosv_34
  v_add_u32 v18, s40, v11
  v_lshl_add_u32 v18, v18, 11, v8
  s_add_u32 m0, s42, 2048
  v_add_u32 v19, 1024, v18
  buffer_load_dwordx4 v19, s[16:19], 0 offen  lds
  s_add_u32 m0, s42, 3072
  v_add_u32 v19, 1536, v18
  buffer_load_dwordx4 v19, s[16:19], 0 offen  lds
L_p1_nosv_34:
  v_lshrrev_b32 v18, 16, v17
  v_mad_u32_u24 v19, v18, s57, v8
  v_lshl_add_u32 v20, v18, 11, v8
  buffer_load_dwordx4 v[102:105], v19, s[28:31], 0 offen offset:512
  buffer_load_dwordx4 v[106:109], v19, s[28:31], 0 offen offset:1024
  buffer_load_dwordx4 v[110:113], v20, s[16:19], 0 offen offset:1024
  buffer_load_dwordx4 v[114:117], v20, s[16:19], 0 offen offset:1536
  v_and_b32 v125, 0xffff0000, v16
  v_lshlrev_b32 v126, 16, v17
  v_mov_b32 v127, v11
  s_add_u32 s58, s58, 1
  s_cmp_ge_u32 s58, s59
  s_cselect_b32 s73, 1, 0
  s_cbranch_scc1 L_p1_adv_next_35
  v_add_u32 v12, 16, v12
  v_add_u32 v13, 16, v13
  v_add_u32 v14, 16, v14
  s_and_b32 s54, s58, 7
  s_cmp_lg_u32 s54, 0
  s_cbranch_scc1 L_p1_adv_done_36
  s_waitcnt lgkmcnt(0)
  v_subrev_u32 v12, 128, v12
  v_subrev_u32 v13, 128, v13
  v_subrev_u32 v14, 128, v14
  v_and_b32 v66, 7, v1
  v_lshlrev_b32 v67, 2, v11
  ds_read_b32 v67, v67 offset:28800
  v_add_u32 v68, s40, v11
  v_add_u32 v69, s58, v66
  s_cmp_ge_u32 s58, 32
  s_cbranch_scc1 L_p1_rf_ovf_37
  v_mul_u32_u24 v70, 384, v68
  v_lshl_add_u32 v70, v69, 4, v70
  v_subrev_u32 v70, 128, v70
  buffer_load_dwordx4 v[74:77], v70, s[36:39], 0 offen
  s_waitcnt vmcnt(0) lgkmcnt(0)
  v_cmp_gt_u32 vcc, v67, v69
  s_nop 1
  s_branch L_p1_rf_join_38
L_p1_rf_ovf_37:
  v_subrev_u32 v69, 32, v69
  v_lshlrev_b32 v70, 5, v69
  buffer_load_dwordx4 v[74:77], v70, s[44:47], 0 offen
  buffer_load_dword v71, v70, s[44:47], 0 offen offset:16
  s_waitcnt vmcnt(0) lgkmcnt(0)
  v_cmp_eq_u32 vcc, v71, v68
  v_cmp_gt_u32 s[54:55], s56, v69
  s_nop 0
  s_and_b64 vcc, vcc, s[54:55]
  v_cmp_lt_u32 s[54:55], 32, v67
  s_nop 0
  s_and_b64 vcc, vcc, s[54:55]
L_p1_rf_join_38:
  v_cndmask_b32 v74, 0, v74, vcc
  v_cndmask_b32 v75, 0, v75, vcc
  v_cndmask_b32 v76, 0, v76, vcc
  v_mov_b32 v70, 0xffff0000
  v_cndmask_b32 v77, v70, v77, vcc
  v_lshl_add_u32 v70, v66, 4, v12
  ds_write_b128 v70, v[74:77] offset:0
  s_waitcnt lgkmcnt(0)
  s_branch L_p1_adv_done_36
L_p1_adv_next_35:
  s_mov_b32 s58, 0
  v_mov_b32 v4, 0
  v_mov_b32 v5, 1
  s_mov_b64 exec, 1
  ds_add_rtn_u32 v4, v4, v5 offset:29984
  s_mov_b64 exec, -1
  s_waitcnt lgkmcnt(0)
  v_readfirstlane_b32 s60, v4
  s_mov_b32 s59, 0
  s_cmp_ge_u32 s60, 10
  s_cbranch_scc1 L_p1_sg_fin_39
  s_lshl_b32 s61, s60, 5
  v_add_u32 v4, s61, v2
  v_add_u32 v5, s61, v3
  s_lshl_b32 s61, s60, 2
  v_mov_b32 v6, s61
  ds_read_b32 v11, v4 offset:29568
  ds_read_b32 v13, v5 offset:29568
  ds_read_b32 v14, v5 offset:29572
  ds_read_b32 v6, v6 offset:29888
  v_mov_b32 v7, 80
  s_waitcnt lgkmcnt(0)
  v_cndmask_b32 v13, v7, v13, s[48:49]
  v_cndmask_b32 v14, v7, v14, s[48:49]
  v_readfirstlane_b32 s59, v6
  v_lshlrev_b32 v12, 7, v11
  v_lshlrev_b32 v13, 7, v13
  v_lshlrev_b32 v14, 7, v14
  s_min_u32 s59, s59, s50
  s_cmp_ge_u32 s59, 8
  s_cbranch_scc0 L_p1_sg_lo_40
  s_setprio 3
  s_branch L_p1_sg_fin_39
L_p1_sg_lo_40:
  s_setprio 0
L_p1_sg_fin_39:
L_p1_adv_done_36:
L_p1_noiss2_33:
  s_branch L_p1_loop
L_p1_end:
L_k2_fin:
L_k2_exit:
  s_endpgm
.section .rodata,"a"
.p2align 6
.amdhsa_kernel k1_kernel
  .amdhsa_next_free_vgpr 224
  .amdhsa_next_free_sgpr 102
  .amdhsa_accum_offset 224
  .amdhsa_group_segment_fixed_size 0
  .amdhsa_kernarg_size 88
  .amdhsa_user_sgpr_count 2
  .amdhsa_user_sgpr_kernarg_segment_ptr 1
  .amdhsa_system_sgpr_workgroup_id_x 1
.end_amdhsa_kernel
.p2align 6
.amdhsa_kernel k2_kernel
  .amdhsa_next_free_vgpr 128
  .amdhsa_next_free_sgpr 102
  .amdhsa_accum_offset 128
  .amdhsa_group_segment_fixed_size 0
  .amdhsa_kernarg_size 88
  .amdhsa_user_sgpr_count 2
  .amdhsa_user_sgpr_kernarg_segment_ptr 1
  .amdhsa_system_sgpr_workgroup_id_x 1
.end_amdhsa_kernel
```
